```python
import torch

def _softmax(x, axis=-1):
    return torch.softmax(x, dim=axis)
def _gelu(x):
    return torch.nn.functional.gelu(x, approximate="tanh")
def _silu(x):
    return torch.nn.functional.silu(x)
def _sigmoid(x):
    return torch.sigmoid(x)
def _layernorm(x, axis=-1, eps=1e-5):
    m = x.mean(dim=axis, keepdim=True)
    v = x.var(dim=axis, keepdim=True, unbiased=False)
    return (x - m) / torch.sqrt(v + eps)
def _scatter_add(tgt, idx, src, axis=0):
    return tgt.clone().index_add_(axis, idx, src)
def _segment_sum(src, seg, n):
    out = torch.zeros((n,) + src.shape[1:], dtype=src.dtype)
    return out.index_add_(0, seg, src)
def _pad(x, pw):
    flat = tuple(v for pair in reversed(pw) for v in pair)
    return torch.nn.functional.pad(x, flat)

kernel_name = 'gated_mix__ssm_conv_s4d__glu_gated_reglu__prompt'

def setup_inputs():

    _w = (lambda a: (lambda t: t.to(torch.bfloat16) if t.is_floating_point() else t)(torch.as_tensor(a)))
    def _A_setup():
        Bsz, L, D, N = 1, 2048, 512, 128
        return {
            "u": _w((lambda *s: torch.randn(*s, dtype=torch.bfloat16) * 0.05)(Bsz, L, D)),
            "log_A_real": _w((lambda *s: torch.randn(*s, dtype=torch.bfloat16) * 3.2)(D, N) * 0.5),
            "A_imag": _w((lambda *s: torch.randn(*s, dtype=torch.bfloat16) * 0.05)(D, N) * 3.14),
            "C_real": _w((lambda *s: torch.randn(*s, dtype=torch.bfloat16) * 0.05)(D, N) / N ** 0.5),
            "C_imag": _w((lambda *s: torch.randn(*s, dtype=torch.bfloat16) * 0.1)(D, N) / N ** 0.5),
            "log_dt": _w((lambda *s: torch.randn(*s, dtype=torch.bfloat16) * 0.05)(D) * 0.5 - 4.0),
            "D_skip": _w((lambda *s: torch.randn(*s, dtype=torch.bfloat16) * 0.05)(D)),
        }
    _A_in = _A_setup()

    def _B_setup():
        B, S, D, F = 1, 2048, 512, 1792
        return {
            "x": _w((lambda *s: torch.randn(*s, dtype=torch.bfloat16) * 0.05)(B, S, D)),
            "W_gate": _w((lambda *s: torch.randn(*s, dtype=torch.bfloat16) * 0.8)(D, F) * (2.0 / D) ** 0.5),
            "W_up": _w((lambda *s: torch.randn(*s, dtype=torch.bfloat16) * 0.8)(D, F) * (2.0 / D) ** 0.5),
            "W_down": _w((lambda *s: torch.randn(*s, dtype=torch.bfloat16) * 0.8)(F, D) * (1.0 / F) ** 0.5),
        }
    _B_in = _B_setup()

    return {
        "A_u": _A_in["u"],
        "A_log_A_real": _A_in["log_A_real"],
        "A_A_imag": _A_in["A_imag"],
        "A_C_real": _A_in["C_real"],
        "A_C_imag": _A_in["C_imag"],
        "A_log_dt": _A_in["log_dt"],
        "A_D_skip": _A_in["D_skip"],
        "B_x": _B_in["x"],
        "B_W_gate": _B_in["W_gate"],
        "B_W_up": _B_in["W_up"],
        "B_W_down": _B_in["W_down"],
        "gate_w": _w((lambda *s: torch.randn(*s, dtype=torch.bfloat16) * 0.05)(512) * 16.0),
    }

def reference(A_u, A_log_A_real, A_A_imag, A_C_real, A_C_imag, A_log_dt, A_D_skip, B_x, B_W_gate, B_W_up, B_W_down, gate_w):
    def _A_ref(u, log_A_real, A_imag, C_real, C_imag, log_dt, D_skip):
        L = u.shape[1]
        dt = torch.exp(log_dt)
        A = -torch.exp(log_A_real) + 1j * A_imag
        C = (C_real + 1j * C_imag) * dt[:, None]
        pos = (lambda x, dt: x.to(dt))(torch.arange(L), log_dt.dtype)
        P = torch.exp((A * dt[:, None])[:, :, None] * pos[None, None, :])
        K = 2.0 * torch.einsum("dn,dnl->dl", C, P).real
        L2 = 2 * L
        u_t = (lambda x, *d: x.permute(*d))(u, 0, 2, 1)
        Kf = (lambda x, *a, **k: torch.fft.rfft(x.float(), *a, **k))(K, L2)
        Uf = (lambda x, *a, **k: torch.fft.rfft(x.float(), *a, **k))(u_t, L2)
        y = (lambda x, *a, **k: torch.fft.irfft(x, *a, **k).to(torch.bfloat16))(Uf * Kf[None, :, :], L2)[:, :, :L]
        y = (lambda x, *d: x.permute(*d))(y, 0, 2, 1)
        return y + u * D_skip[None, None, :]

    def _B_ref(x, W_gate, W_up, W_down):
        gate = torch.einsum("bsd,df->bsf", x, W_gate)
        up = torch.einsum("bsd,df->bsf", x, W_up)
        gate = gate * (lambda x, dt: x.to(dt))(gate > 0, gate.dtype)
        h = gate * up
        return torch.einsum("bsf,fd->bsd", h, W_down)

    x = A_u
    g = _sigmoid((x * gate_w).sum(-1, keepdims=True))
    a = _A_ref(x, A_log_A_real, A_A_imag, A_C_real, A_C_imag, A_log_dt, A_D_skip)
    b = _B_ref(x, B_W_gate, B_W_up, B_W_down)
    return g * a + (1 - g) * b
```

```asm
; @launch grid=(256,1,1) block=(256,1,1) lds=163840
.amdgcn_target "amdgcn-amd-amdhsa--gfx950"
.text
.globl gated_mix__ssm_conv_s4d__glu_gated_reglu__prompt_kernel
.p2align 8
.type gated_mix__ssm_conv_s4d__glu_gated_reglu__prompt_kernel,@function
gated_mix__ssm_conv_s4d__glu_gated_reglu__prompt_kernel:
    s_cmp_lt_u32 s2, 256
    s_cbranch_scc1 L_go_1
    s_endpgm
L_go_1:
    s_load_dwordx16 s[4:19], s[0:1], 0
    s_load_dwordx8 s[20:27], s[0:1], 64
    s_load_dwordx4 s[28:31], s[0:1], 96
    s_load_dwordx2 s[32:33], s[0:1], 112
    s_lshr_b32 s65, s2, 3
    s_getpc_b64 s[82:83]
L_pc:
    v_and_b32 v2, 7, v0
    v_lshl_add_u32 v2, s65, 3, v2
    v_min_u32 v2, (L_end-L_pc-4)/128, v2
    v_lshlrev_b32 v2, 7, v2
    v_mov_b32 v3, s83
    v_add_co_u32 v2, vcc, s82, v2
    s_nop 1
    v_addc_co_u32 v3, vcc, 0, v3, vcc
    global_load_dword v254, v[2:3], off
    v_lshrrev_b32 v1, 6, v0
    v_and_b32 v255, 63, v0
    v_readfirstlane_b32 s66, v1
    s_and_b32 s64, s2, 7
    s_and_b32 s80, s65, 3
    s_lshr_b32 s70, s65, 2
    s_lshr_b32 s81, s64, 2
    s_lshl_b32 s81, s81, 2
    s_add_u32 s67, s81, s80
    s_and_b32 s81, s64, 3
    s_mul_i32 s81, s81, 7
    s_add_u32 s68, s81, s70
    s_lshl_b32 s81, s64, 2
    s_add_u32 s69, s81, s80
    s_add_u32 s71, s80, s70
    s_mul_i32 s82, s71, 86
    s_lshr_b32 s82, s82, 8
    s_mul_i32 s82, s82, 3
    s_sub_u32 s71, s71, s82
    s_mul_i32 s71, s71, 3
    s_and_b32 s71, s71, 7
    s_mov_b32 s38, 0x200000
    s_mov_b32 s39, 0x00020000
    s_mov_b32 s42, 0x1c0000
    s_mov_b32 s43, 0x00020000
    s_mov_b32 s46, 0x1c0000
    s_mov_b32 s47, 0x00020000
    s_lshl_b32 s77, s64, 5
    s_add_u32 s77, s77, s65
    s_cmp_ge_u32 s65, 28
    s_cbranch_scc1 L_spare_2
    s_lshl_b32 s80, s77, 2
    s_add_u32 s80, s80, s66
    s_lshl_b32 s81, s80, 7
    v_lshl_add_u32 v192, v255, 1, s81
    s_lshr_b32 s80, s80, 1
    s_lshl_b32 s80, s80, 1
    v_mov_b32 v193, s80
    s_waitcnt lgkmcnt(0)
    global_load_short_d16_hi v196, v192, s[6:7]
    global_load_short_d16_hi v197, v192, s[8:9]
    global_load_short_d16_hi v198, v192, s[10:11]
    global_load_short_d16_hi v199, v192, s[12:13]
    global_load_short_d16_hi v200, v193, s[14:15]
    global_load_short_d16_hi v201, v193, s[16:17]
    v_lshrrev_b32 v192, 3, v255
    v_and_b32 v193, 7, v255
    v_lshrrev_b32 v194, 1, v192
    v_xor_b32 v195, v193, v194
    v_lshlrev_b32 v195, 4, v195
    v_lshl_add_u32 v195, v192, 10, v195
    s_lshl_b32 s80, s67, 2
    s_add_u32 s80, s80, s66
    s_lshl_b32 s80, s80, 16
    v_add_u32 v182, s80, v195
    v_xor_b32 v183, 64, v182
    v_add_u32 v189, 54272, v183
    v_add_u32 v188, 47104, v182
    v_add_u32 v187, 39936, v183
    v_add_u32 v186, 32768, v182
    v_add_u32 v185, 21504, v183
    v_add_u32 v184, 14336, v182
    v_add_u32 v183, 7168, v183
    v_and_b32 v194, 1, v194
    v_lshlrev_b32 v194, 2, v194
    v_xor_b32 v194, v193, v194
    v_lshlrev_b32 v194, 4, v194
    v_mul_u32_u24 v192, 3584, v192
    s_mul_i32 s80, s66, 57344
    s_lshl_b32 s81, s68, 7
    s_add_u32 s80, s80, s81
    v_add3_u32 v190, v192, v194, s80
    v_add_u32 v191, 27648, v190
    s_lshl_b32 s74, s66, 13
    s_lshl_b32 s75, s66, 11
    s_add_u32 s75, s75, 98304
    s_mov_b64 s[36:37], s[4:5]
    s_mov_b64 s[40:41], s[20:21]
    s_mov_b64 s[44:45], s[22:23]
    s_add_u32 s80, s71, 0
    s_and_b32 s80, s80, 7
    s_lshl_b32 s72, s80, 7
    s_mul_i32 s73, s80, 229376
    s_add_u32 m0, s75, 0
    s_nop 0
    buffer_load_dwordx4 v190, s[40:43], s73 offen offset:0  lds
    buffer_load_dwordx4 v191, s[40:43], s73 offen offset:1024  lds
    s_add_u32 m0, s75, 8192
    s_nop 0
    buffer_load_dwordx4 v190, s[44:47], s73 offen offset:0  lds
    buffer_load_dwordx4 v191, s[44:47], s73 offen offset:1024  lds
    s_add_u32 m0, s74, 0
    s_mov_b32 s76, s69
    s_mov_b32 s48, s32
    s_mov_b32 s49, s33
    s_mov_b32 s50, 0x10000000
    s_mov_b32 s51, 0x00020000
    s_mov_b32 s52, s28
    s_mov_b32 s53, s29
    s_mov_b32 s54, 0x200000
    s_mov_b32 s55, 0x00020000
    s_mov_b32 s60, s30
    s_mov_b32 s61, s31
    s_mov_b32 s62, 0x100
    s_mov_b32 s63, 0x00020000
    v_and_b32 v192, 31, v255
    v_lshrrev_b32 v193, 5, v255
    v_bfe_u32 v194, v255, 1, 3
    v_xor_b32 v194, v194, v193
    v_lshlrev_b32 v194, 4, v194
    v_lshl_add_u32 v194, v192, 7, v194
    v_add_u32 v176, s74, v194
    v_xor_b32 v177, 32, v176
    v_xor_b32 v178, 64, v176
    v_xor_b32 v179, 96, v176
    v_bfe_u32 v192, v255, 2, 2
    v_lshl_add_u32 v192, v193, 3, v192
    v_bfe_u32 v193, v255, 4, 1
    v_bfe_u32 v194, v255, 1, 1
    v_lshl_add_u32 v193, v193, 1, v194
    v_bfe_u32 v194, v255, 3, 1
    v_lshl_add_u32 v193, v194, 2, v193
    v_and_b32 v194, 1, v255
    v_lshlrev_b32 v194, 3, v194
    v_lshl_add_u32 v194, v193, 4, v194
    v_lshl_add_u32 v194, v192, 7, v194
    v_add_u32 v180, 98304, v194
    v_xor_b32 v181, 64, v180
    s_lshr_b32 s80, s66, 1
    s_and_b32 s81, s66, 1
    s_mul_i32 s82, s80, 2064
    s_add_u32 s82, s82, 159056
    s_lshl_b32 s83, s81, 6
    s_sub_u32 s83, 127, s83
    v_sub_u32 v192, s83, v255
    v_lshlrev_b32 v193, 4, v192
    v_cvt_f32_u32 v195, v193
    v_cvt_pk_bf16_f32 v195, v195, v195
    v_and_b32 v195, 0xffff, v195
    v_subrev_u32 v195, 17024, v195
    v_min_i32 v234, 128, v193
    v_max_i32 v195, v195, v234
    v_lshl_add_u32 v209, v195, 1, s82
    v_subrev_u32 v194, 1, v193
    v_max_i32 v194, 0, v194
    v_cvt_f32_u32 v195, v194
    v_cvt_pk_bf16_f32 v195, v195, v195
    v_and_b32 v195, 0xffff, v195
    v_subrev_u32 v195, 17024, v195
    v_min_i32 v234, 128, v194
    v_max_i32 v195, v195, v234
    v_lshl_add_u32 v218, v195, 1, s82
    s_add_u32 s83, s82, 2048
    v_mov_b32 v194, s83
    v_cmp_eq_u32 vcc, 0, v192
    s_nop 1
    v_cndmask_b32 v218, v218, v194, vcc
    v_ffbh_u32 v194, v192
    v_min_u32 v194, 28, v194
    v_sub_u32 v194, 28, v194
    v_lshlrev_b32 v194, 3, v194
    s_mov_b32 s83, 0x2
    v_bfe_u32 v195, s83, v194, 8
    v_add_u32 v217, v209, v195
    s_mov_b32 s83, 0x204
    v_bfe_u32 v195, s83, v194, 8
    v_add_u32 v208, v209, v195
    s_mov_b32 s83, 0x20406
    v_bfe_u32 v195, s83, v194, 8
    v_add_u32 v216, v209, v195
    s_mov_b32 s83, 0x20408
    v_bfe_u32 v195, s83, v194, 8
    v_add_u32 v207, v209, v195
    s_mov_b32 s83, 0x202040a
    v_bfe_u32 v195, s83, v194, 8
    v_add_u32 v215, v209, v195
    s_mov_b32 s83, 0x204060c
    v_bfe_u32 v195, s83, v194, 8
    v_add_u32 v206, v209, v195
    s_mov_b32 s83, 0x204080e
    v_bfe_u32 v195, s83, v194, 8
    v_add_u32 v214, v209, v195
    s_mov_b32 s83, 0x2040810
    v_bfe_u32 v195, s83, v194, 8
    v_add_u32 v205, v209, v195
    s_mov_b32 s83, 0x2040812
    v_bfe_u32 v195, s83, v194, 8
    v_add_u32 v213, v209, v195
    s_mov_b32 s83, 0x2040a14
    v_bfe_u32 v195, s83, v194, 8
    v_add_u32 v204, v209, v195
    s_mov_b32 s83, 0x2060c16
    v_bfe_u32 v195, s83, v194, 8
    v_add_u32 v212, v209, v195
    s_mov_b32 s83, 0x4060c18
    v_bfe_u32 v195, s83, v194, 8
    v_add_u32 v203, v209, v195
    s_mov_b32 s83, 0x4060c1a
    v_bfe_u32 v195, s83, v194, 8
    v_add_u32 v211, v209, v195
    s_mov_b32 s83, 0x4080e1c
    v_bfe_u32 v195, s83, v194, 8
    v_add_u32 v202, v209, v195
    s_mov_b32 s83, 0x408101e
    v_bfe_u32 v195, s83, v194, 8
    v_add_u32 v210, v209, v195
    v_and_b32 v192, 15, v255
    s_lshl_b32 s83, s81, 4
    v_add_u32 v192, s83, v192
    v_lshrrev_b32 v193, 4, v255
    v_lshlrev_b32 v194, 3, v193
    v_lshl_add_u32 v194, v192, 4, v194
    v_lshlrev_b32 v195, 3, v192
    v_add_u32 v195, 512, v195
    v_cmp_eq_u32 vcc, 2, v193
    s_nop 1
    v_cndmask_b32 v194, v194, v195, vcc
    v_lshlrev_b32 v195, 2, v192
    v_add_u32 v195, 768, v195
    v_mov_b32 v234, 4
    v_mov_b32 v220, 128
    v_cmp_eq_u32 vcc, 3, v193
    s_nop 1
    v_cndmask_b32 v194, v194, v195, vcc
    v_cndmask_b32 v234, v234, v220, vcc
    v_add_u32 v219, s82, v194
    v_add_u32 v220, v219, v234
    v_lshlrev_b32 v194, 8, v193
    v_lshl_add_u32 v194, v192, 1, v194
    v_add_u32 v221, s82, v194
    v_or_b32 v194, v192, v193
    v_mov_b32 v195, 0
    v_cmp_eq_u32 vcc, 0, v194
    s_nop 1
    v_cndmask_b32 v223, v195, 1.0, vcc
    v_mov_b32 v239, 0
    s_cmp_eq_u32 s66, 0
    s_cselect_b64 s[14:15], -1, 0
    s_mov_b32 s8, 0
    s_lshr_b32 s80, s66, 1
    s_mul_i32 s80, s80, 65536
    s_add_u32 s80, s80, 65536
    s_and_b32 s81, s66, 1
    s_mul_i32 s81, s81, 8448
    s_mov_b32 s83, 528
    v_and_b32 v2, 15, v255
    v_lshrrev_b32 v3, 4, v255
    v_lshl_add_u32 v3, v3, 4, s80
    v_mad_u32_u24 v140, v2, s83, v3
    v_min_u32 v2, 4, v2
    v_mad_u32_u24 v142, v2, s83, v3
    v_add_u32 v141, s81, v140
    s_mov_b32 s82, 0x3fb8aa3b
    s_lshr_b32 s80, s66, 1
    s_mul_i32 s81, s80, 2064
    s_add_u32 s81, s81, 161104
    v_mov_b32 v10, s81
    s_mul_i32 s80, s80, 65536
    s_and_b32 s81, s66, 1
    s_lshl_b32 s81, s81, 8
    s_add_u32 s80, s80, s81
    s_add_u32 s80, s80, 65536
    v_lshl_add_u32 v13, v255, 2, s80
    v_mov_b32 v11, 0
    v_mov_b32 v12, 0x3f80
    ds_write_b32 v10, v11
    ds_write_b32 v13, v12
    s_waitcnt vmcnt(5)
    v_mul_f32 v0, 0x3fb8aa3b, v200
    buffer_load_dwordx4 v182, s[36:39], s72 offen offset:0  lds
    v_mul_f32 v2, 0x3fb8aa3b, v196
    v_fma_f32 v1, v200, s82, -v0
    v_fma_f32 v3, v196, s82, -v2
    v_fmac_f32 v1, 0x32a57060, v200
    v_fmac_f32 v3, 0x32a57060, v196
    v_exp_f32 v0, v0
    buffer_load_dwordx4 v183, s[36:39], s72 offen offset:1024  lds
    v_exp_f32 v2, v2
    v_mul_f32 v1, 0x3f317218, v1
    v_mul_f32 v3, 0x3f317218, v3
    v_fmac_f32 v0, v0, v1
    v_fmac_f32 v2, v2, v3
    v_cvt_pk_bf16_f32 v0, v0, v0
    buffer_load_dwordx4 v184, s[36:39], s72 offen offset:2048  lds
    v_cvt_pk_bf16_f32 v2, v2, v2
    v_and_b32 v200, 0xffff0000, v0
    v_and_b32 v196, 0xffff0000, v2
    v_mul_f32 v4, v196, v200
    v_mul_f32 v5, v197, v200
    v_mul_f32 v6, v198, v200
    v_mul_f32 v7, v199, v200
    buffer_load_dwordx4 v185, s[36:39], s72 offen offset:3072  lds
    v_mul_f32 v4, 0xbfb8aa3b, v4
    v_mul_f32 v5, 0x3e22f983, v5
    v_add_f32 v16, v6, v6
    v_add_f32 v17, v7, v7
    s_waitcnt vmcnt(8)
    v_mul_f32 v223, v223, v201
    v_mul_f32 v0, 8.0, v4
    s_add_u32 m0, s74, 4096
    v_mul_f32 v2, 256.0, v4
    v_exp_f32 v8, v4
    v_mul_f32 v1, 8.0, v5
    v_mul_f32 v3, 256.0, v5
    v_fract_f32 v9, v5
    v_exp_f32 v0, v0
    buffer_load_dwordx4 v186, s[36:39], s72 offen offset:0  lds
    v_exp_f32 v2, v2
    v_cos_f32 v122, v9
    v_fract_f32 v1, v1
    v_fract_f32 v3, v3
    v_sin_f32 v123, v9
    v_cos_f32 v60, v1
    v_cos_f32 v128, v3
    buffer_load_dwordx4 v187, s[36:39], s72 offen offset:1024  lds
    v_mul_f32 v122, v122, v8
    v_sin_f32 v61, v1
    v_sin_f32 v129, v3
    v_mul_f32 v123, v123, v8
    v_mul_f32 v60, v60, v0
    v_mul_f32 v128, v128, v2
    buffer_load_dwordx4 v188, s[36:39], s72 offen offset:2048  lds
    v_mul_f32 v61, v61, v0
    v_mul_f32 v129, v129, v2
    v_pk_mul_f32 v[62:63], v[60:61], v[60:61] op_sel:[0,0] op_sel_hi:[0,1]
    v_pk_mul_f32 v[124:125], v[122:123], v[122:123] op_sel:[0,0] op_sel_hi:[0,1]
    v_pk_mul_f32 v[32:33], v[16:17], v[128:129] op_sel:[0,0] op_sel_hi:[0,1]
    v_pk_fma_f32 v[62:63], v[60:61], v[60:61], v[62:63] op_sel:[1,1,0] op_sel_hi:[1,0,1] neg_lo:[0,1,0]
    buffer_load_dwordx4 v189, s[36:39], s72 offen offset:3072  lds
    v_pk_fma_f32 v[124:125], v[122:123], v[122:123], v[124:125] op_sel:[1,1,0] op_sel_hi:[1,0,1] neg_lo:[0,1,0]
    v_pk_fma_f32 v[32:33], v[16:17], v[128:129], v[32:33] op_sel:[1,1,0] op_sel_hi:[1,0,1] neg_lo:[0,1,0]
    v_cvt_pk_bf16_f32 v130, v60, v61
    v_cvt_pk_bf16_f32 v131, v16, -v17
    v_pk_mul_f32 v[18:19], v[16:17], v[122:123] op_sel:[0,0] op_sel_hi:[0,1]
    ds_write_b32 v13, v130 offset:528
    ds_write_b32 v13, v131 offset:16896
    s_add_u32 s80, s71, 1
    s_and_b32 s80, s80, 7
    s_lshl_b32 s72, s80, 7
    s_mul_i32 s73, s80, 229376
    v_pk_fma_f32 v[18:19], v[16:17], v[122:123], v[18:19] op_sel:[1,1,0] op_sel_hi:[1,0,1] neg_lo:[0,1,0]
    v_pk_mul_f32 v[66:67], v[62:63], v[62:63] op_sel:[0,0] op_sel_hi:[0,1]
    v_pk_mul_f32 v[64:65], v[62:63], v[60:61] op_sel:[0,0] op_sel_hi:[0,1]
    v_cvt_pk_bf16_f32 v132, v32, -v33
    v_pk_fma_f32 v[66:67], v[62:63], v[62:63], v[66:67] op_sel:[1,1,0] op_sel_hi:[1,0,1] neg_lo:[0,1,0]
    v_pk_fma_f32 v[64:65], v[62:63], v[60:61], v[64:65] op_sel:[1,1,0] op_sel_hi:[1,0,1] neg_lo:[0,1,0]
    s_add_u32 m0, s75, 16384
    ds_write_b32 v13, v132 offset:21120
    v_cvt_pk_bf16_f32 v130, v62, v63
    v_pk_mul_f32 v[126:127], v[124:125], v[124:125] op_sel:[0,0] op_sel_hi:[0,1]
    v_cvt_pk_bf16_f32 v132, v18, -v19
    ds_write_b32 v13, v130 offset:1056
    v_pk_fma_f32 v[126:127], v[124:125], v[124:125], v[126:127] op_sel:[1,1,0] op_sel_hi:[1,0,1] neg_lo:[0,1,0]
    ds_write_b32 v13, v132 offset:17424
    buffer_load_dwordx4 v190, s[40:43], s73 offen offset:0  lds
    v_pk_mul_f32 v[68:69], v[60:61], v[66:67] op_sel:[0,0] op_sel_hi:[0,1]
    v_pk_mul_f32 v[70:71], v[62:63], v[66:67] op_sel:[0,0] op_sel_hi:[0,1]
    v_pk_mul_f32 v[72:73], v[64:65], v[66:67] op_sel:[0,0] op_sel_hi:[0,1]
    v_pk_mul_f32 v[74:75], v[66:67], v[66:67] op_sel:[0,0] op_sel_hi:[0,1]
    v_pk_mul_f32 v[20:21], v[18:19], v[122:123] op_sel:[0,0] op_sel_hi:[0,1]
    v_pk_mul_f32 v[40:41], v[32:33], v[128:129] op_sel:[0,0] op_sel_hi:[0,1]
    v_pk_fma_f32 v[68:69], v[60:61], v[66:67], v[68:69] op_sel:[1,1,0] op_sel_hi:[1,0,1] neg_lo:[0,1,0]
    v_pk_fma_f32 v[70:71], v[62:63], v[66:67], v[70:71] op_sel:[1,1,0] op_sel_hi:[1,0,1] neg_lo:[0,1,0]
    v_pk_fma_f32 v[72:73], v[64:65], v[66:67], v[72:73] op_sel:[1,1,0] op_sel_hi:[1,0,1] neg_lo:[0,1,0]
    v_pk_fma_f32 v[74:75], v[66:67], v[66:67], v[74:75] op_sel:[1,1,0] op_sel_hi:[1,0,1] neg_lo:[0,1,0]
    v_pk_fma_f32 v[20:21], v[18:19], v[122:123], v[20:21] op_sel:[1,1,0] op_sel_hi:[1,0,1] neg_lo:[0,1,0]
    v_pk_fma_f32 v[40:41], v[32:33], v[128:129], v[40:41] op_sel:[1,1,0] op_sel_hi:[1,0,1] neg_lo:[0,1,0]
    v_pk_mul_f32 v[76:77], v[68:69], v[66:67] op_sel:[0,0] op_sel_hi:[0,1]
    v_pk_mul_f32 v[78:79], v[70:71], v[66:67] op_sel:[0,0] op_sel_hi:[0,1]
    v_cvt_pk_bf16_f32 v135, v64, v65
    v_cvt_pk_bf16_f32 v136, v66, v67
    v_cvt_pk_bf16_f32 v137, v20, -v21
    v_cvt_pk_bf16_f32 v138, v40, -v41
    v_pk_fma_f32 v[76:77], v[68:69], v[66:67], v[76:77] op_sel:[1,1,0] op_sel_hi:[1,0,1] neg_lo:[0,1,0]
    v_pk_fma_f32 v[78:79], v[70:71], v[66:67], v[78:79] op_sel:[1,1,0] op_sel_hi:[1,0,1] neg_lo:[0,1,0]
    ds_write_b32 v13, v135 offset:1584
    ds_write_b32 v13, v136 offset:2112
    ds_write_b32 v13, v137 offset:17952
    ds_write_b32 v13, v138 offset:23232
    v_cvt_pk_bf16_f32 v133, v68, v69
    v_cvt_pk_bf16_f32 v134, v70, v71
    v_pk_mul_f32 v[80:81], v[72:73], v[66:67] op_sel:[0,0] op_sel_hi:[0,1]
    v_pk_mul_f32 v[82:83], v[74:75], v[66:67] op_sel:[0,0] op_sel_hi:[0,1]
    v_pk_mul_f32 v[22:23], v[20:21], v[122:123] op_sel:[0,0] op_sel_hi:[0,1]
    v_pk_mul_f32 v[42:43], v[40:41], v[126:127] op_sel:[0,0] op_sel_hi:[0,1]
    ds_write_b32 v13, v133 offset:2640
    ds_write_b32 v13, v134 offset:3168
    v_pk_fma_f32 v[80:81], v[72:73], v[66:67], v[80:81] op_sel:[1,1,0] op_sel_hi:[1,0,1] neg_lo:[0,1,0]
    v_pk_fma_f32 v[82:83], v[74:75], v[66:67], v[82:83] op_sel:[1,1,0] op_sel_hi:[1,0,1] neg_lo:[0,1,0]
    v_pk_fma_f32 v[22:23], v[20:21], v[122:123], v[22:23] op_sel:[1,1,0] op_sel_hi:[1,0,1] neg_lo:[0,1,0]
    v_pk_fma_f32 v[42:43], v[40:41], v[126:127], v[42:43] op_sel:[1,1,0] op_sel_hi:[1,0,1] neg_lo:[0,1,0]
    v_pk_mul_f32 v[84:85], v[76:77], v[66:67] op_sel:[0,0] op_sel_hi:[0,1]
    v_pk_mul_f32 v[86:87], v[78:79], v[66:67] op_sel:[0,0] op_sel_hi:[0,1]
    v_cvt_pk_bf16_f32 v135, v72, v73
    v_cvt_pk_bf16_f32 v136, v74, v75
    v_cvt_pk_bf16_f32 v137, v22, -v23
    v_cvt_pk_bf16_f32 v138, v42, -v43
    v_pk_fma_f32 v[84:85], v[76:77], v[66:67], v[84:85] op_sel:[1,1,0] op_sel_hi:[1,0,1] neg_lo:[0,1,0]
    v_pk_fma_f32 v[86:87], v[78:79], v[66:67], v[86:87] op_sel:[1,1,0] op_sel_hi:[1,0,1] neg_lo:[0,1,0]
    ds_write_b32 v13, v135 offset:3696
    ds_write_b32 v13, v136 offset:4224
    ds_write_b32 v13, v137 offset:18480
    ds_write_b32 v13, v138 offset:23760
    v_cvt_pk_bf16_f32 v133, v76, v77
    v_cvt_pk_bf16_f32 v134, v78, v79
    v_pk_mul_f32 v[88:89], v[80:81], v[66:67] op_sel:[0,0] op_sel_hi:[0,1]
    v_pk_mul_f32 v[90:91], v[82:83], v[66:67] op_sel:[0,0] op_sel_hi:[0,1]
    v_pk_mul_f32 v[24:25], v[22:23], v[122:123] op_sel:[0,0] op_sel_hi:[0,1]
    v_pk_mul_f32 v[44:45], v[40:41], v[128:129] op_sel:[0,0] op_sel_hi:[0,1]
    ds_write_b32 v13, v133 offset:4752
    ds_write_b32 v13, v134 offset:5280
    v_pk_fma_f32 v[88:89], v[80:81], v[66:67], v[88:89] op_sel:[1,1,0] op_sel_hi:[1,0,1] neg_lo:[0,1,0]
    v_pk_fma_f32 v[90:91], v[82:83], v[66:67], v[90:91] op_sel:[1,1,0] op_sel_hi:[1,0,1] neg_lo:[0,1,0]
    v_pk_fma_f32 v[24:25], v[22:23], v[122:123], v[24:25] op_sel:[1,1,0] op_sel_hi:[1,0,1] neg_lo:[0,1,0]
    v_pk_fma_f32 v[44:45], v[40:41], v[128:129], v[44:45] op_sel:[1,1,0] op_sel_hi:[1,0,1] neg_lo:[0,1,0]
    v_pk_mul_f32 v[92:93], v[84:85], v[66:67] op_sel:[0,0] op_sel_hi:[0,1]
    v_pk_mul_f32 v[94:95], v[86:87], v[66:67] op_sel:[0,0] op_sel_hi:[0,1]
    v_cvt_pk_bf16_f32 v135, v80, v81
    v_cvt_pk_bf16_f32 v136, v82, v83
    v_cvt_pk_bf16_f32 v137, v24, -v25
    v_cvt_pk_bf16_f32 v138, v44, -v45
    v_pk_fma_f32 v[92:93], v[84:85], v[66:67], v[92:93] op_sel:[1,1,0] op_sel_hi:[1,0,1] neg_lo:[0,1,0]
    v_pk_fma_f32 v[94:95], v[86:87], v[66:67], v[94:95] op_sel:[1,1,0] op_sel_hi:[1,0,1] neg_lo:[0,1,0]
    ds_write_b32 v13, v135 offset:5808
    ds_write_b32 v13, v136 offset:6336
    ds_write_b32 v13, v137 offset:19008
    ds_write_b32 v13, v138 offset:24288
    v_cvt_pk_bf16_f32 v133, v84, v85
    v_cvt_pk_bf16_f32 v134, v86, v87
    v_pk_mul_f32 v[96:97], v[88:89], v[66:67] op_sel:[0,0] op_sel_hi:[0,1]
    v_pk_mul_f32 v[98:99], v[90:91], v[66:67] op_sel:[0,0] op_sel_hi:[0,1]
    v_pk_mul_f32 v[26:27], v[24:25], v[122:123] op_sel:[0,0] op_sel_hi:[0,1]
    v_pk_mul_f32 v[46:47], v[44:45], v[126:127] op_sel:[0,0] op_sel_hi:[0,1]
    ds_write_b32 v13, v133 offset:6864
    ds_write_b32 v13, v134 offset:7392
    v_pk_fma_f32 v[96:97], v[88:89], v[66:67], v[96:97] op_sel:[1,1,0] op_sel_hi:[1,0,1] neg_lo:[0,1,0]
    v_pk_fma_f32 v[98:99], v[90:91], v[66:67], v[98:99] op_sel:[1,1,0] op_sel_hi:[1,0,1] neg_lo:[0,1,0]
    v_pk_fma_f32 v[26:27], v[24:25], v[122:123], v[26:27] op_sel:[1,1,0] op_sel_hi:[1,0,1] neg_lo:[0,1,0]
    v_pk_fma_f32 v[46:47], v[44:45], v[126:127], v[46:47] op_sel:[1,1,0] op_sel_hi:[1,0,1] neg_lo:[0,1,0]
    v_pk_mul_f32 v[100:101], v[92:93], v[66:67] op_sel:[0,0] op_sel_hi:[0,1]
    v_pk_mul_f32 v[102:103], v[94:95], v[66:67] op_sel:[0,0] op_sel_hi:[0,1]
    v_cvt_pk_bf16_f32 v135, v88, v89
    v_cvt_pk_bf16_f32 v136, v90, v91
    v_cvt_pk_bf16_f32 v137, v26, -v27
    v_cvt_pk_bf16_f32 v138, v46, -v47
    v_pk_fma_f32 v[100:101], v[92:93], v[66:67], v[100:101] op_sel:[1,1,0] op_sel_hi:[1,0,1] neg_lo:[0,1,0]
    v_pk_fma_f32 v[102:103], v[94:95], v[66:67], v[102:103] op_sel:[1,1,0] op_sel_hi:[1,0,1] neg_lo:[0,1,0]
    ds_write_b32 v13, v135 offset:7920
    ds_write_b32 v13, v136 offset:8448
    ds_write_b32 v13, v137 offset:19536
    ds_write_b32 v13, v138 offset:24816
    v_cvt_pk_bf16_f32 v133, v92, v93
    v_cvt_pk_bf16_f32 v134, v94, v95
    v_pk_mul_f32 v[104:105], v[96:97], v[66:67] op_sel:[0,0] op_sel_hi:[0,1]
    v_pk_mul_f32 v[106:107], v[98:99], v[66:67] op_sel:[0,0] op_sel_hi:[0,1]
    v_pk_mul_f32 v[28:29], v[26:27], v[122:123] op_sel:[0,0] op_sel_hi:[0,1]
    v_pk_mul_f32 v[48:49], v[44:45], v[128:129] op_sel:[0,0] op_sel_hi:[0,1]
    ds_write_b32 v13, v133 offset:8976
    ds_write_b32 v13, v134 offset:9504
    v_pk_fma_f32 v[104:105], v[96:97], v[66:67], v[104:105] op_sel:[1,1,0] op_sel_hi:[1,0,1] neg_lo:[0,1,0]
    v_pk_fma_f32 v[106:107], v[98:99], v[66:67], v[106:107] op_sel:[1,1,0] op_sel_hi:[1,0,1] neg_lo:[0,1,0]
    v_pk_fma_f32 v[28:29], v[26:27], v[122:123], v[28:29] op_sel:[1,1,0] op_sel_hi:[1,0,1] neg_lo:[0,1,0]
    v_pk_fma_f32 v[48:49], v[44:45], v[128:129], v[48:49] op_sel:[1,1,0] op_sel_hi:[1,0,1] neg_lo:[0,1,0]
    v_pk_mul_f32 v[108:109], v[100:101], v[66:67] op_sel:[0,0] op_sel_hi:[0,1]
    v_pk_mul_f32 v[110:111], v[102:103], v[66:67] op_sel:[0,0] op_sel_hi:[0,1]
    v_cvt_pk_bf16_f32 v135, v96, v97
    v_cvt_pk_bf16_f32 v136, v98, v99
    v_cvt_pk_bf16_f32 v137, v28, -v29
    v_cvt_pk_bf16_f32 v138, v48, -v49
    v_pk_fma_f32 v[108:109], v[100:101], v[66:67], v[108:109] op_sel:[1,1,0] op_sel_hi:[1,0,1] neg_lo:[0,1,0]
    v_pk_fma_f32 v[110:111], v[102:103], v[66:67], v[110:111] op_sel:[1,1,0] op_sel_hi:[1,0,1] neg_lo:[0,1,0]
    ds_write_b32 v13, v135 offset:10032
    ds_write_b32 v13, v136 offset:10560
    ds_write_b32 v13, v137 offset:20064
    ds_write_b32 v13, v138 offset:25344
    v_cvt_pk_bf16_f32 v133, v100, v101
    buffer_load_dwordx4 v191, s[40:43], s73 offen offset:1024  lds
    v_cvt_pk_bf16_f32 v134, v102, v103
    v_pk_mul_f32 v[112:113], v[104:105], v[66:67] op_sel:[0,0] op_sel_hi:[0,1]
    v_pk_mul_f32 v[114:115], v[106:107], v[66:67] op_sel:[0,0] op_sel_hi:[0,1]
    v_pk_mul_f32 v[30:31], v[28:29], v[122:123] op_sel:[0,0] op_sel_hi:[0,1]
    s_add_u32 m0, s75, 24576
    v_pk_mul_f32 v[50:51], v[48:49], v[128:129] op_sel:[0,0] op_sel_hi:[0,1]
    ds_write_b32 v13, v133 offset:11088
    ds_write_b32 v13, v134 offset:11616
    v_pk_fma_f32 v[112:113], v[104:105], v[66:67], v[112:113] op_sel:[1,1,0] op_sel_hi:[1,0,1] neg_lo:[0,1,0]
    buffer_load_dwordx4 v190, s[44:47], s73 offen offset:0  lds
    v_pk_fma_f32 v[114:115], v[106:107], v[66:67], v[114:115] op_sel:[1,1,0] op_sel_hi:[1,0,1] neg_lo:[0,1,0]
    v_pk_fma_f32 v[30:31], v[28:29], v[122:123], v[30:31] op_sel:[1,1,0] op_sel_hi:[1,0,1] neg_lo:[0,1,0]
    v_pk_fma_f32 v[50:51], v[48:49], v[128:129], v[50:51] op_sel:[1,1,0] op_sel_hi:[1,0,1] neg_lo:[0,1,0]
    v_pk_mul_f32 v[116:117], v[108:109], v[66:67] op_sel:[0,0] op_sel_hi:[0,1]
    v_pk_mul_f32 v[118:119], v[110:111], v[66:67] op_sel:[0,0] op_sel_hi:[0,1]
    buffer_load_dwordx4 v191, s[44:47], s73 offen offset:1024  lds
    v_cvt_pk_bf16_f32 v135, v104, v105
    v_cvt_pk_bf16_f32 v136, v106, v107
    v_cvt_pk_bf16_f32 v137, v30, -v31
    v_cvt_pk_bf16_f32 v138, v50, -v51
    s_add_u32 m0, s74, 32768
    v_pk_fma_f32 v[116:117], v[108:109], v[66:67], v[116:117] op_sel:[1,1,0] op_sel_hi:[1,0,1] neg_lo:[0,1,0]
    v_pk_fma_f32 v[118:119], v[110:111], v[66:67], v[118:119] op_sel:[1,1,0] op_sel_hi:[1,0,1] neg_lo:[0,1,0]
    ds_write_b32 v13, v135 offset:12144
    ds_write_b32 v13, v136 offset:12672
    ds_write_b32 v13, v137 offset:20592
    buffer_load_dwordx4 v182, s[36:39], s72 offen offset:0  lds
    ds_write_b32 v13, v138 offset:25872
    v_cvt_pk_bf16_f32 v133, v108, v109
    v_cvt_pk_bf16_f32 v134, v110, v111
    v_pk_mul_f32 v[120:121], v[112:113], v[66:67] op_sel:[0,0] op_sel_hi:[0,1]
    buffer_load_dwordx4 v183, s[36:39], s72 offen offset:1024  lds
    v_cvt_pk_bf16_f32 v136, v114, v115
    v_pk_mul_f32 v[34:35], v[32:33], v[124:125] op_sel:[0,0] op_sel_hi:[0,1]
    v_pk_mul_f32 v[52:53], v[50:51], v[128:129] op_sel:[0,0] op_sel_hi:[0,1]
    ds_write_b32 v13, v133 offset:13200
    buffer_load_dwordx4 v184, s[36:39], s72 offen offset:2048  lds
    ds_write_b32 v13, v134 offset:13728
    v_pk_fma_f32 v[120:121], v[112:113], v[66:67], v[120:121] op_sel:[1,1,0] op_sel_hi:[1,0,1] neg_lo:[0,1,0]
    ds_write_b32 v13, v136 offset:14784
    v_pk_fma_f32 v[34:35], v[32:33], v[124:125], v[34:35] op_sel:[1,1,0] op_sel_hi:[1,0,1] neg_lo:[0,1,0]
    v_pk_fma_f32 v[52:53], v[50:51], v[128:129], v[52:53] op_sel:[1,1,0] op_sel_hi:[1,0,1] neg_lo:[0,1,0]
    buffer_load_dwordx4 v185, s[36:39], s72 offen offset:3072  lds
    v_cvt_pk_bf16_f32 v133, v116, v117
    v_cvt_pk_bf16_f32 v134, v118, v119
    v_cvt_pk_bf16_f32 v135, v112, v113
    v_cvt_pk_bf16_f32 v137, v34, -v35
    s_add_u32 m0, s74, 36864
    v_cvt_pk_bf16_f32 v138, v52, -v53
    ds_write_b32 v13, v133 offset:15312
    ds_write_b32 v13, v134 offset:15840
    ds_write_b32 v13, v135 offset:14256
    buffer_load_dwordx4 v186, s[36:39], s72 offen offset:0  lds
    ds_write_b32 v13, v137 offset:21648
    ds_write_b32 v13, v138 offset:26400
    v_cvt_pk_bf16_f32 v135, v120, v121
    v_pk_mul_f32 v[36:37], v[34:35], v[124:125] op_sel:[0,0] op_sel_hi:[0,1]
    v_pk_mul_f32 v[54:55], v[52:53], v[128:129] op_sel:[0,0] op_sel_hi:[0,1]
    buffer_load_dwordx4 v187, s[36:39], s72 offen offset:1024  lds
    ds_write_b32 v13, v135 offset:16368
    v_pk_fma_f32 v[36:37], v[34:35], v[124:125], v[36:37] op_sel:[1,1,0] op_sel_hi:[1,0,1] neg_lo:[0,1,0]
    v_pk_fma_f32 v[54:55], v[52:53], v[128:129], v[54:55] op_sel:[1,1,0] op_sel_hi:[1,0,1] neg_lo:[0,1,0]
    v_cvt_pk_bf16_f32 v137, v36, -v37
    buffer_load_dwordx4 v188, s[36:39], s72 offen offset:2048  lds
    v_cvt_pk_bf16_f32 v138, v54, -v55
    ds_write_b32 v13, v137 offset:22176
    ds_write_b32 v13, v138 offset:26928
    v_pk_mul_f32 v[38:39], v[36:37], v[124:125] op_sel:[0,0] op_sel_hi:[0,1]
    v_pk_mul_f32 v[56:57], v[54:55], v[128:129] op_sel:[0,0] op_sel_hi:[0,1]
    buffer_load_dwordx4 v189, s[36:39], s72 offen offset:3072  lds
    v_pk_fma_f32 v[38:39], v[36:37], v[124:125], v[38:39] op_sel:[1,1,0] op_sel_hi:[1,0,1] neg_lo:[0,1,0]
    v_pk_fma_f32 v[56:57], v[54:55], v[128:129], v[56:57] op_sel:[1,1,0] op_sel_hi:[1,0,1] neg_lo:[0,1,0]
    v_cvt_pk_bf16_f32 v137, v38, -v39
    v_cvt_pk_bf16_f32 v138, v56, -v57
    ds_write_b32 v13, v137 offset:22704
    ds_write_b32 v13, v138 offset:27456
    v_mov_b32 v238, 1
    v_mov_b32 v239, 0
    s_lshl_b32 s9, s66, 3
    s_add_u32 s9, s9, s70
    s_add_u32 s9, s9, 192
    s_lshl_b32 s9, s9, 7
    v_and_b32 v196, 3, v255
    v_lshl_add_u32 v240, v196, 2, s9
    v_lshlrev_b32 v196, 3, v255
    v_add_u32 v241, 28672, v196
    s_lshl_b32 s9, s69, 2
    s_add_u32 s9, s9, s66
    s_waitcnt lgkmcnt(0)
    s_barrier
    ds_read_b128 v[16:19], v141 offset:0
    s_lshl_b32 s9, s9, 7
    v_min_u32 v196, 6, v255
    ds_read_b128 v[20:23], v140 offset:16896
    v_lshl_add_u32 v242, v196, 2, s9
    s_add_u32 s9, s69, 192
    ds_read_b128 v[24:27], v142 offset:25344
    s_lshl_b32 s9, s9, 7
    s_add_u32 s9, s9, 16
    v_and_b32 v196, 3, v255
    ds_read_b128 v[28:31], v141 offset:64
    v_lshl_add_u32 v196, v196, 2, s9
    v_cmp_gt_u32 vcc, 32, v255
    s_nop 1
    v_cndmask_b32 v242, v196, v242, vcc
    ds_read_b128 v[32:35], v140 offset:16960
    s_lshr_b32 s9, s69, 4
    s_lshl_b32 s9, s9, 5
    ds_read_b128 v[36:39], v142 offset:25408
    s_lshl_b32 s10, s70, 2
    s_add_u32 s9, s9, s10
    s_and_b32 s10, s66, 1
    ds_read_b128 v[40:43], v141 offset:128
    s_lshl_b32 s10, s10, 1
    s_add_u32 s9, s9, s10
    ds_read_b128 v[44:47], v140 offset:17024
    s_add_u32 s9, s9, 128
    s_lshl_b32 s9, s9, 7
    v_and_b32 v196, 15, v255
    ds_read_b128 v[48:51], v142 offset:25472
    v_lshl_add_u32 v243, v196, 2, s9
    v_bfe_u32 v196, v255, 4, 1
    ds_read_b128 v[52:55], v141 offset:192
    v_lshl_add_u32 v243, v196, 7, v243
    s_lshl_b32 s9, s77, 1
    ds_read_b128 v[56:59], v140 offset:17088
    s_lshr_b32 s10, s66, 1
    s_add_u32 s9, s9, s10
    s_and_b32 s10, s9, 15
    ds_read_b128 v[60:63], v142 offset:25536
    s_lshr_b32 s9, s9, 4
    s_and_b32 s16, s66, 1
    s_waitcnt lgkmcnt(10)
    v_mfma_f32_16x16x32_bf16 v[4:7], v[20:23], v[16:19], 0
    s_waitcnt lgkmcnt(9)
    v_mfma_f32_16x16x32_bf16 v[8:11], v[24:27], v[16:19], 0
    ds_read_b128 v[64:67], v141 offset:256
    s_lshl_b32 s16, s16, 5
    s_add_u32 s9, s9, s16
    ds_read_b128 v[68:71], v140 offset:17152
    s_add_u32 s9, s9, 128
    s_lshl_b32 s9, s9, 5
    s_add_u32 s9, s9, s10
    ds_read_b128 v[72:75], v142 offset:25600
    s_lshl_b32 s79, s9, 2
    s_lshl_b32 s9, s67, 2
    s_waitcnt lgkmcnt(10)
    v_mfma_f32_16x16x32_bf16 v[4:7], v[32:35], v[28:31], v[4:7]
    s_waitcnt lgkmcnt(9)
    v_mfma_f32_16x16x32_bf16 v[8:11], v[36:39], v[28:31], v[8:11]
    ds_read_b128 v[76:79], v141 offset:320
    s_add_u32 s9, s9, s66
    s_lshl_b32 s9, s9, 2
    s_and_b32 s10, s64, 3
    ds_read_b128 v[80:83], v140 offset:17216
    s_add_u32 s9, s9, s10
    s_lshl_b32 s9, s9, 5
    ds_read_b128 v[84:87], v142 offset:25664
    s_add_u32 s9, s9, s70
    s_lshl_b32 s78, s9, 2
    s_waitcnt lgkmcnt(10)
    v_mfma_f32_16x16x32_bf16 v[4:7], v[44:47], v[40:43], v[4:7]
    s_waitcnt lgkmcnt(9)
    v_mfma_f32_16x16x32_bf16 v[8:11], v[48:51], v[40:43], v[8:11]
    ds_read_b128 v[88:91], v141 offset:384
    v_lshrrev_b32 v196, 5, v255
    v_mul_u32_u24 v196, 4672, v196
    v_and_b32 v197, 31, v255
    ds_read_b128 v[92:95], v140 offset:17280
    v_lshl_add_u32 v196, v197, 4, v196
    v_add_u32 v196, 147712, v196
    ds_read_b128 v[96:99], v142 offset:25728
    v_bfe_u32 v197, v255, 1, 2
    v_mul_u32_u24 v197, 4160, v197
    s_waitcnt lgkmcnt(10)
    v_mfma_f32_16x16x32_bf16 v[4:7], v[56:59], v[52:55], v[4:7]
    s_waitcnt lgkmcnt(9)
    v_mfma_f32_16x16x32_bf16 v[8:11], v[60:63], v[52:55], v[8:11]
    ds_read_b128 v[100:103], v141 offset:448
    v_and_b32 v198, 1, v255
    v_lshl_add_u32 v197, v198, 4, v197
    v_add_u32 v197, 135168, v197
    ds_read_b128 v[104:107], v140 offset:17344
    v_mul_u32_u24 v198, 2064, v198
    v_add_u32 v198, 161104, v198
    ds_read_b128 v[108:111], v142 offset:25792
    v_and_b32 v199, 8, v255
    v_cmp_eq_u32 vcc, 0, v199
    s_nop 1
    v_cndmask_b32 v197, v198, v197, vcc
    s_cmp_eq_u32 s66, 0
    s_cselect_b64 vcc, -1, 0
    v_cndmask_b32 v222, v197, v196, vcc
    s_waitcnt lgkmcnt(10)
    v_mfma_f32_16x16x32_bf16 v[4:7], v[68:71], v[64:67], v[4:7]
    s_waitcnt lgkmcnt(9)
    v_mfma_f32_16x16x32_bf16 v[8:11], v[72:75], v[64:67], v[8:11]
    s_waitcnt lgkmcnt(7)
    v_mfma_f32_16x16x32_bf16 v[4:7], v[80:83], v[76:79], v[4:7]
    s_waitcnt lgkmcnt(6)
    v_mfma_f32_16x16x32_bf16 v[8:11], v[84:87], v[76:79], v[8:11]
    s_waitcnt lgkmcnt(4)
    v_mfma_f32_16x16x32_bf16 v[4:7], v[92:95], v[88:91], v[4:7]
    s_waitcnt lgkmcnt(3)
    v_mfma_f32_16x16x32_bf16 v[8:11], v[96:99], v[88:91], v[8:11]
    s_waitcnt lgkmcnt(1)
    v_mfma_f32_16x16x32_bf16 v[4:7], v[104:107], v[100:103], v[4:7]
    s_waitcnt lgkmcnt(0)
    v_mfma_f32_16x16x32_bf16 v[8:11], v[108:111], v[100:103], v[8:11]
    s_waitcnt vmcnt(12)
    s_barrier
    ds_read_b128 v[128:131], v176 offset:0
    ds_read_b64_tr_b16 v[144:145], v180 offset:0
    ds_read_b64_tr_b16 v[146:147], v180 offset:512
    ds_read_b64_tr_b16 v[148:149], v181 offset:0
    ds_read_b64_tr_b16 v[150:151], v181 offset:512
    ds_read_b64_tr_b16 v[152:153], v180 offset:8192
    ds_read_b64_tr_b16 v[154:155], v180 offset:8704
    ds_read_b64_tr_b16 v[156:157], v181 offset:8192
    ds_read_b64_tr_b16 v[158:159], v181 offset:8704
    ds_read_b128 v[132:135], v176 offset:4096
    v_add_f32 v4, v4, v223
    v_cvt_pk_bf16_f32 v5, v4, v5
    v_cvt_pk_bf16_f32 v6, v6, v7
    v_cvt_pk_bf16_f32 v8, v8, v9
    v_cvt_pk_bf16_f32 v10, v10, v11
    ds_write_b32 v219, v5
    ds_write_b32 v220, v6
    ds_write_b16 v221, v8 offset:1024
    ds_write_b16_d16_hi v221, v8 offset:1088
    ds_write_b16 v221, v10 offset:1152
    ds_write_b16_d16_hi v221, v10 offset:1216
    s_waitcnt lgkmcnt(13)
    v_mfma_f32_32x32x16_bf16 v[0:15], v[144:147], v[128:131], 0
    ds_read_b128 v[136:139], v177 offset:0
    ds_read_b64_tr_b16 v[160:161], v180 offset:2048
    s_add_u32 s80, s71, 2
    s_and_b32 s80, s80, 7
    s_lshl_b32 s72, s80, 7
    s_mul_i32 s73, s80, 229376
    s_add_u32 m0, s75, 32768
    s_waitcnt lgkmcnt(13)
    v_mfma_f32_32x32x16_bf16 v[16:31], v[148:151], v[128:131], 0
    ds_read_b64_tr_b16 v[162:163], v180 offset:2560
    ds_read_b64_tr_b16 v[164:165], v181 offset:2048
    buffer_load_dwordx4 v190, s[40:43], s73 offen offset:0  lds
    s_waitcnt lgkmcnt(13)
    v_mfma_f32_32x32x16_bf16 v[32:47], v[152:155], v[128:131], 0
    ds_read_b64_tr_b16 v[166:167], v181 offset:2560
    ds_read_b64_tr_b16 v[168:169], v180 offset:10240
    buffer_load_dwordx4 v191, s[40:43], s73 offen offset:1024  lds
    s_add_u32 m0, s75, 40960
    s_waitcnt lgkmcnt(13)
    v_mfma_f32_32x32x16_bf16 v[48:63], v[156:159], v[128:131], 0
    ds_read_b64_tr_b16 v[170:171], v180 offset:10752
    ds_read_b64_tr_b16 v[172:173], v181 offset:10240
    buffer_load_dwordx4 v190, s[44:47], s73 offen offset:0  lds
    s_waitcnt lgkmcnt(14)
    v_mfma_f32_32x32x16_bf16 v[64:79], v[144:147], v[132:135], 0
    ds_read_b64_tr_b16 v[174:175], v181 offset:10752
    ds_read_b128 v[140:143], v177 offset:4096
    buffer_load_dwordx4 v191, s[44:47], s73 offen offset:1024  lds
    v_mfma_f32_32x32x16_bf16 v[80:95], v[148:151], v[132:135], 0
    s_add_u32 m0, s74, 65536
    s_nop 0
    buffer_load_dwordx4 v182, s[36:39], s72 offen offset:0  lds
    v_mfma_f32_32x32x16_bf16 v[96:111], v[152:155], v[132:135], 0
    buffer_load_dwordx4 v183, s[36:39], s72 offen offset:1024  lds
    v_mfma_f32_32x32x16_bf16 v[112:127], v[156:159], v[132:135], 0
    buffer_load_dwordx4 v184, s[36:39], s72 offen offset:2048  lds
    s_waitcnt lgkmcnt(7)
    v_mfma_f32_32x32x16_bf16 v[0:15], v[160:163], v[136:139], v[0:15]
    ds_read_b128 v[128:131], v178 offset:0
    ds_read_b64_tr_b16 v[144:145], v180 offset:4096
    buffer_load_dwordx4 v185, s[36:39], s72 offen offset:3072  lds
    s_waitcnt lgkmcnt(7)
    v_mfma_f32_32x32x16_bf16 v[16:31], v[164:167], v[136:139], v[16:31]
    ds_read_b64_tr_b16 v[146:147], v180 offset:4608
    ds_read_b64_tr_b16 v[148:149], v181 offset:4096
    s_add_u32 m0, s74, 69632
    s_waitcnt lgkmcnt(7)
    v_mfma_f32_32x32x16_bf16 v[32:47], v[168:171], v[136:139], v[32:47]
    ds_read_b64_tr_b16 v[150:151], v181 offset:4608
    ds_read_b64_tr_b16 v[152:153], v180 offset:12288
    buffer_load_dwordx4 v186, s[36:39], s72 offen offset:0  lds
    s_waitcnt lgkmcnt(7)
    v_mfma_f32_32x32x16_bf16 v[48:63], v[172:175], v[136:139], v[48:63]
    ds_read_b64_tr_b16 v[154:155], v180 offset:12800
    ds_read_b64_tr_b16 v[156:157], v181 offset:12288
    s_waitcnt lgkmcnt(8)
    v_mfma_f32_32x32x16_bf16 v[64:79], v[160:163], v[140:143], v[64:79]
    ds_read_b64_tr_b16 v[158:159], v181 offset:12800
    ds_read_b128 v[132:135], v178 offset:4096
    buffer_load_dwordx4 v187, s[36:39], s72 offen offset:1024  lds
    v_mfma_f32_32x32x16_bf16 v[80:95], v[164:167], v[140:143], v[80:95]
    buffer_load_dwordx4 v188, s[36:39], s72 offen offset:2048  lds
    v_mfma_f32_32x32x16_bf16 v[96:111], v[168:171], v[140:143], v[96:111]
    buffer_load_dwordx4 v189, s[36:39], s72 offen offset:3072  lds
    v_mfma_f32_32x32x16_bf16 v[112:127], v[172:175], v[140:143], v[112:127]
    s_waitcnt lgkmcnt(7)
    v_mfma_f32_32x32x16_bf16 v[0:15], v[144:147], v[128:131], v[0:15]
    ds_read_b128 v[136:139], v179 offset:0
    ds_read_b64_tr_b16 v[160:161], v180 offset:6144
    s_waitcnt lgkmcnt(7)
    v_mfma_f32_32x32x16_bf16 v[16:31], v[148:151], v[128:131], v[16:31]
    ds_read_b64_tr_b16 v[162:163], v180 offset:6656
    ds_read_b64_tr_b16 v[164:165], v181 offset:6144
    s_waitcnt lgkmcnt(7)
    v_mfma_f32_32x32x16_bf16 v[32:47], v[152:155], v[128:131], v[32:47]
    ds_read_b64_tr_b16 v[166:167], v181 offset:6656
    ds_read_b64_tr_b16 v[168:169], v180 offset:14336
    s_waitcnt lgkmcnt(7)
    v_mfma_f32_32x32x16_bf16 v[48:63], v[156:159], v[128:131], v[48:63]
    ds_read_b64_tr_b16 v[170:171], v180 offset:14848
    ds_read_b64_tr_b16 v[172:173], v181 offset:14336
    s_waitcnt lgkmcnt(8)
    v_mfma_f32_32x32x16_bf16 v[64:79], v[144:147], v[132:135], v[64:79]
    ds_read_b64_tr_b16 v[174:175], v181 offset:14848
    ds_read_b128 v[140:143], v179 offset:4096
    v_mfma_f32_32x32x16_bf16 v[80:95], v[148:151], v[132:135], v[80:95]
    v_mfma_f32_32x32x16_bf16 v[96:111], v[152:155], v[132:135], v[96:111]
    v_mfma_f32_32x32x16_bf16 v[112:127], v[156:159], v[132:135], v[112:127]
    s_waitcnt lgkmcnt(7)
    v_mfma_f32_32x32x16_bf16 v[0:15], v[160:163], v[136:139], v[0:15]
    s_waitcnt lgkmcnt(5)
    v_mfma_f32_32x32x16_bf16 v[16:31], v[164:167], v[136:139], v[16:31]
    s_waitcnt lgkmcnt(0)
    s_waitcnt vmcnt(12)
    s_barrier
    ds_read_b128 v[128:131], v176 offset:32768
    ds_read_b64_tr_b16 v[144:145], v180 offset:16384
    s_mov_b64 exec, s[14:15]
    buffer_load_dword v244, v239, s[60:63], 0 offen sc1
    s_mov_b64 exec, -1
    v_mfma_f32_32x32x16_bf16 v[32:47], v[168:171], v[136:139], v[32:47]
    ds_read_b64_tr_b16 v[146:147], v180 offset:16896
    ds_read_b64_tr_b16 v[148:149], v181 offset:16384
    v_mfma_f32_32x32x16_bf16 v[48:63], v[172:175], v[136:139], v[48:63]
    ds_read_b64_tr_b16 v[150:151], v181 offset:16896
    ds_read_b64_tr_b16 v[152:153], v180 offset:24576
    v_mfma_f32_32x32x16_bf16 v[64:79], v[160:163], v[140:143], v[64:79]
    ds_read_b64_tr_b16 v[154:155], v180 offset:25088
    ds_read_b64_tr_b16 v[156:157], v181 offset:24576
    v_mfma_f32_32x32x16_bf16 v[80:95], v[164:167], v[140:143], v[80:95]
    ds_read_b64_tr_b16 v[158:159], v181 offset:25088
    ds_read_b128 v[132:135], v176 offset:36864
    v_mfma_f32_32x32x16_bf16 v[96:111], v[168:171], v[140:143], v[96:111]
    s_add_u32 s80, s71, 3
    s_and_b32 s80, s80, 7
    s_lshl_b32 s72, s80, 7
    s_mul_i32 s73, s80, 229376
    s_add_u32 m0, s75, 0
    v_mfma_f32_32x32x16_bf16 v[112:127], v[172:175], v[140:143], v[112:127]
    buffer_load_dwordx4 v190, s[40:43], s73 offen offset:0  lds
    buffer_load_dwordx4 v191, s[40:43], s73 offen offset:1024  lds
    s_waitcnt lgkmcnt(7)
    v_mfma_f32_32x32x16_bf16 v[0:15], v[144:147], v[128:131], v[0:15]
    ds_read_b128 v[136:139], v177 offset:32768
    ds_read_b64_tr_b16 v[160:161], v180 offset:18432
    s_waitcnt lgkmcnt(7)
    v_mfma_f32_32x32x16_bf16 v[16:31], v[148:151], v[128:131], v[16:31]
    ds_read_b64_tr_b16 v[162:163], v180 offset:18944
    ds_read_b64_tr_b16 v[164:165], v181 offset:18432
    s_waitcnt lgkmcnt(7)
    v_mfma_f32_32x32x16_bf16 v[32:47], v[152:155], v[128:131], v[32:47]
    ds_read_b64_tr_b16 v[166:167], v181 offset:18944
    ds_read_b64_tr_b16 v[168:169], v180 offset:26624
    s_waitcnt lgkmcnt(7)
    v_mfma_f32_32x32x16_bf16 v[48:63], v[156:159], v[128:131], v[48:63]
    ds_read_b64_tr_b16 v[170:171], v180 offset:27136
    ds_read_b64_tr_b16 v[172:173], v181 offset:26624
    s_waitcnt lgkmcnt(8)
    v_mfma_f32_32x32x16_bf16 v[64:79], v[144:147], v[132:135], v[64:79]
    ds_read_b64_tr_b16 v[174:175], v181 offset:27136
    ds_read_b128 v[140:143], v177 offset:36864
    v_mfma_f32_32x32x16_bf16 v[80:95], v[148:151], v[132:135], v[80:95]
    s_add_u32 m0, s75, 8192
    s_nop 0
    buffer_load_dwordx4 v190, s[44:47], s73 offen offset:0  lds
    buffer_load_dwordx4 v191, s[44:47], s73 offen offset:1024  lds
    v_mfma_f32_32x32x16_bf16 v[96:111], v[152:155], v[132:135], v[96:111]
    s_add_u32 m0, s74, 0
    s_nop 0
    buffer_load_dwordx4 v182, s[36:39], s72 offen offset:0  lds
    v_mfma_f32_32x32x16_bf16 v[112:127], v[156:159], v[132:135], v[112:127]
    buffer_load_dwordx4 v183, s[36:39], s72 offen offset:1024  lds
    buffer_load_dwordx4 v184, s[36:39], s72 offen offset:2048  lds
    s_waitcnt lgkmcnt(7)
    v_mfma_f32_32x32x16_bf16 v[0:15], v[160:163], v[136:139], v[0:15]
    ds_read_b128 v[128:131], v178 offset:32768
    ds_read_b64_tr_b16 v[144:145], v180 offset:20480
    s_waitcnt lgkmcnt(7)
    v_mfma_f32_32x32x16_bf16 v[16:31], v[164:167], v[136:139], v[16:31]
    ds_read_b64_tr_b16 v[146:147], v180 offset:20992
    ds_read_b64_tr_b16 v[148:149], v181 offset:20480
    s_waitcnt lgkmcnt(7)
    v_mfma_f32_32x32x16_bf16 v[32:47], v[168:171], v[136:139], v[32:47]
    ds_read_b64_tr_b16 v[150:151], v181 offset:20992
    ds_read_b64_tr_b16 v[152:153], v180 offset:28672
    s_waitcnt lgkmcnt(7)
    v_mfma_f32_32x32x16_bf16 v[48:63], v[172:175], v[136:139], v[48:63]
    ds_read_b64_tr_b16 v[154:155], v180 offset:29184
    ds_read_b64_tr_b16 v[156:157], v181 offset:28672
    s_waitcnt lgkmcnt(8)
    v_mfma_f32_32x32x16_bf16 v[64:79], v[160:163], v[140:143], v[64:79]
    ds_read_b64_tr_b16 v[158:159], v181 offset:29184
    ds_read_b128 v[132:135], v178 offset:36864
    v_mfma_f32_32x32x16_bf16 v[80:95], v[164:167], v[140:143], v[80:95]
    buffer_load_dwordx4 v185, s[36:39], s72 offen offset:3072  lds
    s_add_u32 m0, s74, 4096
    v_mfma_f32_32x32x16_bf16 v[96:111], v[168:171], v[140:143], v[96:111]
    buffer_load_dwordx4 v186, s[36:39], s72 offen offset:0  lds
    buffer_load_dwordx4 v187, s[36:39], s72 offen offset:1024  lds
    v_mfma_f32_32x32x16_bf16 v[112:127], v[172:175], v[140:143], v[112:127]
    buffer_load_dwordx4 v188, s[36:39], s72 offen offset:2048  lds
    buffer_load_dwordx4 v189, s[36:39], s72 offen offset:3072  lds
    s_waitcnt lgkmcnt(7)
    v_mfma_f32_32x32x16_bf16 v[0:15], v[144:147], v[128:131], v[0:15]
    ds_read_b128 v[136:139], v179 offset:32768
    ds_read_b64_tr_b16 v[160:161], v180 offset:22528
    s_lshr_b32 s20, s66, 1
    s_waitcnt lgkmcnt(7)
    v_mfma_f32_32x32x16_bf16 v[16:31], v[148:151], v[128:131], v[16:31]
    ds_read_b64_tr_b16 v[162:163], v180 offset:23040
    ds_read_b64_tr_b16 v[164:165], v181 offset:22528
    s_and_b32 s21, s66, 1
    s_waitcnt lgkmcnt(7)
    v_mfma_f32_32x32x16_bf16 v[32:47], v[152:155], v[128:131], v[32:47]
    ds_read_b64_tr_b16 v[166:167], v181 offset:23040
    ds_read_b64_tr_b16 v[168:169], v180 offset:30720
    s_lshl_b32 s21, s21, 8
    s_waitcnt lgkmcnt(7)
    v_mfma_f32_32x32x16_bf16 v[48:63], v[156:159], v[128:131], v[48:63]
    ds_read_b64_tr_b16 v[170:171], v180 offset:31232
    ds_read_b64_tr_b16 v[172:173], v181 offset:30720
    s_mul_i32 s22, s20, 8320
    s_waitcnt lgkmcnt(8)
    v_mfma_f32_32x32x16_bf16 v[64:79], v[144:147], v[132:135], v[64:79]
    ds_read_b64_tr_b16 v[174:175], v181 offset:31232
    ds_read_b128 v[140:143], v179 offset:36864
    s_sub_u32 s22, s22, s21
    v_mfma_f32_32x32x16_bf16 v[80:95], v[148:151], v[132:135], v[80:95]
    s_add_u32 s22, s22, 138588
    v_mfma_f32_32x32x16_bf16 v[96:111], v[152:155], v[132:135], v[96:111]
    s_mul_i32 s23, s20, 4672
    v_mfma_f32_32x32x16_bf16 v[112:127], v[156:159], v[132:135], v[112:127]
    s_waitcnt lgkmcnt(7)
    v_mfma_f32_32x32x16_bf16 v[0:15], v[160:163], v[136:139], v[0:15]
    s_waitcnt lgkmcnt(5)
    v_mfma_f32_32x32x16_bf16 v[16:31], v[164:167], v[136:139], v[16:31]
    s_mov_b64 exec, s[14:15]
    s_waitcnt vmcnt(12)
    v_cmp_ne_u32 vcc, 1, v244
    s_mov_b64 exec, -1
    s_nop 3
    s_cbranch_vccnz L_slow_4
L_ret_5:
    s_waitcnt lgkmcnt(0)
    s_barrier
    v_add_u32 v176, 0x10000, v176
    ds_read_b128 v[128:131], v176 offset:0
    ds_read_b64_tr_b16 v[144:145], v180 offset:32768
    v_mfma_f32_32x32x16_bf16 v[32:47], v[168:171], v[136:139], v[32:47]
    ds_read_b64_tr_b16 v[146:147], v180 offset:33280
    ds_read_b64_tr_b16 v[148:149], v181 offset:32768
    v_mfma_f32_32x32x16_bf16 v[48:63], v[172:175], v[136:139], v[48:63]
    ds_read_b64_tr_b16 v[150:151], v181 offset:33280
    ds_read_b64_tr_b16 v[152:153], v180 offset:40960
    v_mfma_f32_32x32x16_bf16 v[64:79], v[160:163], v[140:143], v[64:79]
    ds_read_b64_tr_b16 v[154:155], v180 offset:41472
    ds_read_b64_tr_b16 v[156:157], v181 offset:40960
    v_mfma_f32_32x32x16_bf16 v[80:95], v[164:167], v[140:143], v[80:95]
    ds_read_b64_tr_b16 v[158:159], v181 offset:41472
    ds_read_b128 v[132:135], v176 offset:4096
    v_mfma_f32_32x32x16_bf16 v[96:111], v[168:171], v[140:143], v[96:111]
    s_add_u32 s80, s71, 4
    s_and_b32 s80, s80, 7
    s_lshl_b32 s72, s80, 7
    s_mul_i32 s73, s80, 229376
    s_add_u32 m0, s75, 16384
    s_nop 0
    buffer_load_dwordx4 v190, s[40:43], s73 offen offset:0  lds
    v_mfma_f32_32x32x16_bf16 v[112:127], v[172:175], v[140:143], v[112:127]
    buffer_load_dwordx4 v191, s[40:43], s73 offen offset:1024  lds
    s_waitcnt lgkmcnt(7)
    v_mfma_f32_32x32x16_bf16 v[0:15], v[144:147], v[128:131], v[0:15]
    v_add_u32 v177, 0x10000, v177
    ds_read_b128 v[136:139], v177 offset:0
    ds_read_b64_tr_b16 v[160:161], v180 offset:34816
    s_sub_u32 s23, s23, s21
    s_waitcnt lgkmcnt(7)
    v_mfma_f32_32x32x16_bf16 v[16:31], v[148:151], v[128:131], v[16:31]
    ds_read_b64_tr_b16 v[162:163], v180 offset:35328
    ds_read_b64_tr_b16 v[164:165], v181 offset:34816
    s_add_u32 s23, s23, 148000
    s_waitcnt lgkmcnt(7)
    v_mfma_f32_32x32x16_bf16 v[32:47], v[152:155], v[128:131], v[32:47]
    ds_read_b64_tr_b16 v[166:167], v181 offset:35328
    ds_read_b64_tr_b16 v[168:169], v180 offset:43008
    v_and_b32 v192, 15, v255
    s_waitcnt lgkmcnt(7)
    v_mfma_f32_32x32x16_bf16 v[48:63], v[156:159], v[128:131], v[48:63]
    ds_read_b64_tr_b16 v[170:171], v180 offset:43520
    ds_read_b64_tr_b16 v[172:173], v181 offset:43008
    v_lshrrev_b32 v193, 4, v255
    s_waitcnt lgkmcnt(8)
    v_mfma_f32_32x32x16_bf16 v[64:79], v[144:147], v[132:135], v[64:79]
    ds_read_b64_tr_b16 v[174:175], v181 offset:43520
    ds_read_b128 v[140:143], v177 offset:4096
    v_lshlrev_b32 v193, 4, v193
    v_mfma_f32_32x32x16_bf16 v[80:95], v[148:151], v[132:135], v[80:95]
    s_add_u32 m0, s75, 24576
    s_nop 0
    buffer_load_dwordx4 v190, s[44:47], s73 offen offset:0  lds
    v_lshl_add_u32 v194, v192, 5, v193
    v_mfma_f32_32x32x16_bf16 v[96:111], v[152:155], v[132:135], v[96:111]
    buffer_load_dwordx4 v191, s[44:47], s73 offen offset:1024  lds
    v_add_u32 v252, s23, v194
    v_mfma_f32_32x32x16_bf16 v[112:127], v[156:159], v[132:135], v[112:127]
    s_add_u32 m0, s74, 32768
    s_nop 0
    buffer_load_dwordx4 v182, s[36:39], s72 offen offset:0  lds
    v_and_b32 v194, 1, v255
    s_waitcnt lgkmcnt(7)
    v_mfma_f32_32x32x16_bf16 v[0:15], v[160:163], v[136:139], v[0:15]
    v_add_u32 v178, 0x10000, v178
    ds_read_b128 v[128:131], v178 offset:0
    ds_read_b64_tr_b16 v[144:145], v180 offset:36864
    v_mul_u32_u24 v194, 4158, v194
    s_waitcnt lgkmcnt(7)
    v_mfma_f32_32x32x16_bf16 v[16:31], v[164:167], v[136:139], v[16:31]
    ds_read_b64_tr_b16 v[146:147], v180 offset:37376
    ds_read_b64_tr_b16 v[148:149], v181 offset:36864
    v_lshl_add_u32 v194, v192, 1, v194
    s_waitcnt lgkmcnt(7)
    v_mfma_f32_32x32x16_bf16 v[32:47], v[168:171], v[136:139], v[32:47]
    ds_read_b64_tr_b16 v[150:151], v181 offset:37376
    ds_read_b64_tr_b16 v[152:153], v180 offset:45056
    v_sub_u32 v194, v193, v194
    s_waitcnt lgkmcnt(7)
    v_mfma_f32_32x32x16_bf16 v[48:63], v[172:175], v[136:139], v[48:63]
    ds_read_b64_tr_b16 v[154:155], v180 offset:45568
    ds_read_b64_tr_b16 v[156:157], v181 offset:45056
    v_add_u32 v248, s22, v194
    s_waitcnt lgkmcnt(8)
    v_mfma_f32_32x32x16_bf16 v[64:79], v[160:163], v[140:143], v[64:79]
    ds_read_b64_tr_b16 v[158:159], v181 offset:45568
    ds_read_b128 v[132:135], v178 offset:4096
    v_subrev_u32 v249, 1024, v248
    v_mfma_f32_32x32x16_bf16 v[80:95], v[164:167], v[140:143], v[80:95]
    buffer_load_dwordx4 v183, s[36:39], s72 offen offset:1024  lds
    v_subrev_u32 v250, 2048, v248
    v_mfma_f32_32x32x16_bf16 v[96:111], v[168:171], v[140:143], v[96:111]
    buffer_load_dwordx4 v184, s[36:39], s72 offen offset:2048  lds
    v_subrev_u32 v251, 3072, v248
    v_mfma_f32_32x32x16_bf16 v[112:127], v[172:175], v[140:143], v[112:127]
    buffer_load_dwordx4 v185, s[36:39], s72 offen offset:3072  lds
    s_waitcnt lgkmcnt(7)
    v_mfma_f32_32x32x16_bf16 v[0:15], v[144:147], v[128:131], v[0:15]
    v_add_u32 v179, 0x10000, v179
    ds_read_b128 v[136:139], v179 offset:0
    ds_read_b64_tr_b16 v[160:161], v180 offset:38912
    s_lshl_b32 s20, s66, 13
    s_waitcnt lgkmcnt(7)
    v_mfma_f32_32x32x16_bf16 v[16:31], v[148:151], v[128:131], v[16:31]
    ds_read_b64_tr_b16 v[162:163], v180 offset:39424
    ds_read_b64_tr_b16 v[164:165], v181 offset:38912
    v_lshrrev_b32 v192, 5, v255
    s_waitcnt lgkmcnt(7)
    v_mfma_f32_32x32x16_bf16 v[32:47], v[152:155], v[128:131], v[32:47]
    ds_read_b64_tr_b16 v[166:167], v181 offset:39424
    ds_read_b64_tr_b16 v[168:169], v180 offset:47104
    v_lshlrev_b32 v192, 3, v192
    s_waitcnt lgkmcnt(7)
    v_mfma_f32_32x32x16_bf16 v[48:63], v[156:159], v[128:131], v[48:63]
    ds_read_b64_tr_b16 v[170:171], v180 offset:47616
    ds_read_b64_tr_b16 v[172:173], v181 offset:47104
    v_xor_b32 v192, v192, v255
    s_waitcnt lgkmcnt(8)
    v_mfma_f32_32x32x16_bf16 v[64:79], v[144:147], v[132:135], v[64:79]
    ds_read_b64_tr_b16 v[174:175], v181 offset:47616
    ds_read_b128 v[140:143], v179 offset:4096
    s_add_u32 m0, s74, 36864
    s_nop 0
    buffer_load_dwordx4 v186, s[36:39], s72 offen offset:0  lds
    v_lshl_add_u32 v246, v192, 4, s20
    v_mfma_f32_32x32x16_bf16 v[80:95], v[148:151], v[132:135], v[80:95]
    buffer_load_dwordx4 v187, s[36:39], s72 offen offset:1024  lds
    s_lshr_b32 s20, s66, 1
    v_mfma_f32_32x32x16_bf16 v[96:111], v[152:155], v[132:135], v[96:111]
    buffer_load_dwordx4 v188, s[36:39], s72 offen offset:2048  lds
    s_lshl_b32 s20, s20, 14
    v_mfma_f32_32x32x16_bf16 v[112:127], v[156:159], v[132:135], v[112:127]
    buffer_load_dwordx4 v189, s[36:39], s72 offen offset:3072  lds
    s_and_b32 s21, s66, 1
    s_waitcnt lgkmcnt(7)
    v_mfma_f32_32x32x16_bf16 v[0:15], v[160:163], v[136:139], v[0:15]
    s_lshl_b32 s21, s21, 12
    s_waitcnt lgkmcnt(5)
    v_mfma_f32_32x32x16_bf16 v[16:31], v[164:167], v[136:139], v[16:31]
    s_waitcnt lgkmcnt(0)
    s_waitcnt vmcnt(12)
    s_barrier
    v_subrev_u32 v176, 0x10000, v176
    ds_read_b128 v[128:131], v176 offset:0
    ds_read_b64_tr_b16 v[144:145], v180 offset:0
    buffer_load_dword v253, v240, s[48:51], 0 offen sc1
    s_add_u32 s20, s20, s21
    v_mfma_f32_32x32x16_bf16 v[32:47], v[168:171], v[136:139], v[32:47]
    ds_read_b64_tr_b16 v[146:147], v180 offset:512
    ds_read_b64_tr_b16 v[148:149], v181 offset:0
    v_and_b32 v192, 1, v255
    v_mfma_f32_32x32x16_bf16 v[48:63], v[172:175], v[136:139], v[48:63]
    ds_read_b64_tr_b16 v[150:151], v181 offset:512
    ds_read_b64_tr_b16 v[152:153], v180 offset:8192
    v_bfe_u32 v193, v255, 1, 4
    v_mfma_f32_32x32x16_bf16 v[64:79], v[160:163], v[140:143], v[64:79]
    ds_read_b64_tr_b16 v[154:155], v180 offset:8704
    ds_read_b64_tr_b16 v[156:157], v181 offset:8192
    v_lshl_add_u32 v193, v192, 5, v193
    v_mfma_f32_32x32x16_bf16 v[80:95], v[164:167], v[140:143], v[80:95]
    ds_read_b64_tr_b16 v[158:159], v181 offset:8704
    ds_read_b128 v[132:135], v176 offset:4096
    v_lshlrev_b32 v192, 3, v192
    v_mfma_f32_32x32x16_bf16 v[96:111], v[168:171], v[140:143], v[96:111]
    s_add_u32 s80, s71, 5
    s_and_b32 s80, s80, 7
    s_lshl_b32 s72, s80, 7
    s_mul_i32 s73, s80, 229376
    s_add_u32 m0, s75, 32768
    s_nop 0
    buffer_load_dwordx4 v190, s[40:43], s73 offen offset:0  lds
    v_xor_b32 v193, v193, v192
    v_mfma_f32_32x32x16_bf16 v[112:127], v[172:175], v[140:143], v[112:127]
    buffer_load_dwordx4 v191, s[40:43], s73 offen offset:1024  lds
    s_waitcnt lgkmcnt(7)
    v_mfma_f32_32x32x16_bf16 v[0:15], v[144:147], v[128:131], v[0:15]
    v_subrev_u32 v177, 0x10000, v177
    ds_read_b128 v[136:139], v177 offset:0
    ds_read_b64_tr_b16 v[160:161], v180 offset:2048
    v_lshrrev_b32 v192, 5, v255
    s_waitcnt lgkmcnt(7)
    v_mfma_f32_32x32x16_bf16 v[16:31], v[148:151], v[128:131], v[16:31]
    ds_read_b64_tr_b16 v[162:163], v180 offset:2560
    ds_read_b64_tr_b16 v[164:165], v181 offset:2048
    v_lshl_add_u32 v193, v192, 6, v193
    s_waitcnt lgkmcnt(7)
    v_mfma_f32_32x32x16_bf16 v[32:47], v[152:155], v[128:131], v[32:47]
    ds_read_b64_tr_b16 v[166:167], v181 offset:2560
    ds_read_b64_tr_b16 v[168:169], v180 offset:10240
    v_lshl_add_u32 v247, v193, 4, s20
    s_waitcnt lgkmcnt(7)
    v_mfma_f32_32x32x16_bf16 v[48:63], v[156:159], v[128:131], v[48:63]
    ds_read_b64_tr_b16 v[170:171], v180 offset:10752
    ds_read_b64_tr_b16 v[172:173], v181 offset:10240
    v_lshlrev_b32 v234, 4, v255
    s_waitcnt lgkmcnt(8)
    v_mfma_f32_32x32x16_bf16 v[64:79], v[144:147], v[132:135], v[64:79]
    ds_read_b64_tr_b16 v[174:175], v181 offset:10752
    ds_read_b128 v[140:143], v177 offset:4096
    s_lshl_b32 s20, s77, 2
    v_mfma_f32_32x32x16_bf16 v[80:95], v[148:151], v[132:135], v[80:95]
    s_add_u32 m0, s75, 40960
    s_nop 0
    buffer_load_dwordx4 v190, s[44:47], s73 offen offset:0  lds
    s_add_u32 s20, s20, s66
    v_mfma_f32_32x32x16_bf16 v[96:111], v[152:155], v[132:135], v[96:111]
    buffer_load_dwordx4 v191, s[44:47], s73 offen offset:1024  lds
    s_lshl_b32 s20, s20, 11
    v_mfma_f32_32x32x16_bf16 v[112:127], v[156:159], v[132:135], v[112:127]
    s_add_u32 m0, s74, 65536
    s_nop 0
    buffer_load_dwordx4 v182, s[36:39], s72 offen offset:0  lds
    s_add_u32 s13, s20, 13631488
    s_waitcnt lgkmcnt(7)
    v_mfma_f32_32x32x16_bf16 v[0:15], v[160:163], v[136:139], v[0:15]
    v_subrev_u32 v178, 0x10000, v178
    ds_read_b128 v[128:131], v178 offset:0
    ds_read_b64_tr_b16 v[144:145], v180 offset:4096
    s_waitcnt lgkmcnt(7)
    v_mfma_f32_32x32x16_bf16 v[16:31], v[164:167], v[136:139], v[16:31]
    ds_read_b64_tr_b16 v[146:147], v180 offset:4608
    ds_read_b64_tr_b16 v[148:149], v181 offset:4096
    s_waitcnt lgkmcnt(7)
    v_mfma_f32_32x32x16_bf16 v[32:47], v[168:171], v[136:139], v[32:47]
    ds_read_b64_tr_b16 v[150:151], v181 offset:4608
    ds_read_b64_tr_b16 v[152:153], v180 offset:12288
    s_waitcnt lgkmcnt(7)
    v_mfma_f32_32x32x16_bf16 v[48:63], v[172:175], v[136:139], v[48:63]
    ds_read_b64_tr_b16 v[154:155], v180 offset:12800
    ds_read_b64_tr_b16 v[156:157], v181 offset:12288
    s_waitcnt lgkmcnt(8)
    v_mfma_f32_32x32x16_bf16 v[64:79], v[160:163], v[140:143], v[64:79]
    ds_read_b64_tr_b16 v[158:159], v181 offset:12800
    ds_read_b128 v[132:135], v178 offset:4096
    v_mfma_f32_32x32x16_bf16 v[80:95], v[164:167], v[140:143], v[80:95]
    buffer_load_dwordx4 v183, s[36:39], s72 offen offset:1024  lds
    v_mfma_f32_32x32x16_bf16 v[96:111], v[168:171], v[140:143], v[96:111]
    buffer_load_dwordx4 v184, s[36:39], s72 offen offset:2048  lds
    v_mfma_f32_32x32x16_bf16 v[112:127], v[172:175], v[140:143], v[112:127]
    buffer_load_dwordx4 v185, s[36:39], s72 offen offset:3072  lds
    s_waitcnt lgkmcnt(7)
    v_mfma_f32_32x32x16_bf16 v[0:15], v[144:147], v[128:131], v[0:15]
    v_subrev_u32 v179, 0x10000, v179
    ds_read_b128 v[136:139], v179 offset:0
    ds_read_b64_tr_b16 v[160:161], v180 offset:6144
    s_waitcnt lgkmcnt(7)
    v_mfma_f32_32x32x16_bf16 v[16:31], v[148:151], v[128:131], v[16:31]
    ds_read_b64_tr_b16 v[162:163], v180 offset:6656
    ds_read_b64_tr_b16 v[164:165], v181 offset:6144
    s_waitcnt lgkmcnt(7)
    v_mfma_f32_32x32x16_bf16 v[32:47], v[152:155], v[128:131], v[32:47]
    ds_read_b64_tr_b16 v[166:167], v181 offset:6656
    ds_read_b64_tr_b16 v[168:169], v180 offset:14336
    s_waitcnt lgkmcnt(7)
    v_mfma_f32_32x32x16_bf16 v[48:63], v[156:159], v[128:131], v[48:63]
    ds_read_b64_tr_b16 v[170:171], v180 offset:14848
    ds_read_b64_tr_b16 v[172:173], v181 offset:14336
    s_waitcnt lgkmcnt(8)
    v_mfma_f32_32x32x16_bf16 v[64:79], v[144:147], v[132:135], v[64:79]
    ds_read_b64_tr_b16 v[174:175], v181 offset:14848
    ds_read_b128 v[140:143], v179 offset:4096
    s_add_u32 m0, s74, 69632
    s_nop 0
    buffer_load_dwordx4 v186, s[36:39], s72 offen offset:0  lds
    v_mfma_f32_32x32x16_bf16 v[80:95], v[148:151], v[132:135], v[80:95]
    buffer_load_dwordx4 v187, s[36:39], s72 offen offset:1024  lds
    v_mfma_f32_32x32x16_bf16 v[96:111], v[152:155], v[132:135], v[96:111]
    buffer_load_dwordx4 v188, s[36:39], s72 offen offset:2048  lds
    v_mfma_f32_32x32x16_bf16 v[112:127], v[156:159], v[132:135], v[112:127]
    buffer_load_dwordx4 v189, s[36:39], s72 offen offset:3072  lds
    s_waitcnt lgkmcnt(7)
    v_mfma_f32_32x32x16_bf16 v[0:15], v[160:163], v[136:139], v[0:15]
    s_waitcnt lgkmcnt(5)
    v_mfma_f32_32x32x16_bf16 v[16:31], v[164:167], v[136:139], v[16:31]
    s_waitcnt lgkmcnt(0)
    s_waitcnt vmcnt(13)
    s_barrier
    ds_read_b128 v[128:131], v176 offset:32768
    ds_read_b64_tr_b16 v[144:145], v180 offset:16384
    s_waitcnt vmcnt(12)
    v_cmp_ne_u32 vcc, 1, v253
    s_nop 4
    s_cbranch_vccnz L_slow_7
L_ret_8:
    s_lshl_b32 s80, s70, 2
    s_add_u32 s80, s80, s66
    s_mul_i32 s80, s80, 57344
    s_add_u32 s80, s80, 1048576
    s_add_u32 s5, s80, 57344
    s_lshl_b32 s81, s8, 12
    s_add_u32 s4, s80, s81
    s_and_b32 s81, s66, 1
    s_lshl_b32 s81, s81, 10
    v_lshl_add_u32 v236, v255, 4, s81
    v_xor_b32 v237, 1024, v236
    v_mfma_f32_32x32x16_bf16 v[32:47], v[168:171], v[136:139], v[32:47]
    ds_read_b64_tr_b16 v[146:147], v180 offset:16896
    ds_read_b64_tr_b16 v[148:149], v181 offset:16384
    v_mfma_f32_32x32x16_bf16 v[48:63], v[172:175], v[136:139], v[48:63]
    ds_read_b64_tr_b16 v[150:151], v181 offset:16896
    ds_read_b64_tr_b16 v[152:153], v180 offset:24576
    v_mfma_f32_32x32x16_bf16 v[64:79], v[160:163], v[140:143], v[64:79]
    ds_read_b64_tr_b16 v[154:155], v180 offset:25088
    ds_read_b64_tr_b16 v[156:157], v181 offset:24576
    v_mfma_f32_32x32x16_bf16 v[80:95], v[164:167], v[140:143], v[80:95]
    ds_read_b64_tr_b16 v[158:159], v181 offset:25088
    ds_read_b128 v[132:135], v176 offset:36864
    v_mfma_f32_32x32x16_bf16 v[96:111], v[168:171], v[140:143], v[96:111]
    s_add_u32 s80, s71, 6
    s_and_b32 s80, s80, 7
    s_lshl_b32 s72, s80, 7
    s_mul_i32 s73, s80, 229376
    s_add_u32 m0, s75, 0
    s_nop 0
    buffer_load_dwordx4 v190, s[40:43], s73 offen offset:0  lds
    v_mfma_f32_32x32x16_bf16 v[112:127], v[172:175], v[140:143], v[112:127]
    buffer_load_dwordx4 v191, s[40:43], s73 offen offset:1024  lds
    s_waitcnt lgkmcnt(7)
    v_mfma_f32_32x32x16_bf16 v[0:15], v[144:147], v[128:131], v[0:15]
    ds_read_b128 v[136:139], v177 offset:32768
    ds_read_b64_tr_b16 v[160:161], v180 offset:18432
    s_waitcnt lgkmcnt(7)
    v_mfma_f32_32x32x16_bf16 v[16:31], v[148:151], v[128:131], v[16:31]
    ds_read_b64_tr_b16 v[162:163], v180 offset:18944
    ds_read_b64_tr_b16 v[164:165], v181 offset:18432
    s_waitcnt lgkmcnt(7)
    v_mfma_f32_32x32x16_bf16 v[32:47], v[152:155], v[128:131], v[32:47]
    ds_read_b64_tr_b16 v[166:167], v181 offset:18944
    ds_read_b64_tr_b16 v[168:169], v180 offset:26624
    s_waitcnt lgkmcnt(7)
    v_mfma_f32_32x32x16_bf16 v[48:63], v[156:159], v[128:131], v[48:63]
    ds_read_b64_tr_b16 v[170:171], v180 offset:27136
    ds_read_b64_tr_b16 v[172:173], v181 offset:26624
    buffer_load_dwordx4 a[0:3], v236, s[48:51], s4 offen offset:0 sc1
    s_waitcnt lgkmcnt(8)
    v_mfma_f32_32x32x16_bf16 v[64:79], v[144:147], v[132:135], v[64:79]
    ds_read_b64_tr_b16 v[174:175], v181 offset:27136
    ds_read_b128 v[140:143], v177 offset:36864
    buffer_load_dwordx4 a[4:7], v237, s[48:51], s4 offen offset:0 sc1
    v_mfma_f32_32x32x16_bf16 v[80:95], v[148:151], v[132:135], v[80:95]
    s_add_u32 m0, s75, 8192
    s_nop 0
    buffer_load_dwordx4 v190, s[44:47], s73 offen offset:0  lds
    v_mfma_f32_32x32x16_bf16 v[96:111], v[152:155], v[132:135], v[96:111]
    buffer_load_dwordx4 v191, s[44:47], s73 offen offset:1024  lds
    v_mfma_f32_32x32x16_bf16 v[112:127], v[156:159], v[132:135], v[112:127]
    s_add_u32 m0, s74, 0
    s_nop 0
    buffer_load_dwordx4 v182, s[36:39], s72 offen offset:0  lds
    s_waitcnt lgkmcnt(7)
    v_mfma_f32_32x32x16_bf16 v[0:15], v[160:163], v[136:139], v[0:15]
    ds_read_b128 v[128:131], v178 offset:32768
    ds_read_b64_tr_b16 v[144:145], v180 offset:20480
    s_waitcnt lgkmcnt(7)
    v_mfma_f32_32x32x16_bf16 v[16:31], v[164:167], v[136:139], v[16:31]
    ds_read_b64_tr_b16 v[146:147], v180 offset:20992
    ds_read_b64_tr_b16 v[148:149], v181 offset:20480
    s_waitcnt lgkmcnt(7)
    v_mfma_f32_32x32x16_bf16 v[32:47], v[168:171], v[136:139], v[32:47]
    ds_read_b64_tr_b16 v[150:151], v181 offset:20992
    ds_read_b64_tr_b16 v[152:153], v180 offset:28672
    s_waitcnt lgkmcnt(7)
    v_mfma_f32_32x32x16_bf16 v[48:63], v[172:175], v[136:139], v[48:63]
    ds_read_b64_tr_b16 v[154:155], v180 offset:29184
    ds_read_b64_tr_b16 v[156:157], v181 offset:28672
    buffer_load_dwordx4 a[8:11], v236, s[48:51], s4 offen offset:2048 sc1
    s_waitcnt lgkmcnt(8)
    v_mfma_f32_32x32x16_bf16 v[64:79], v[160:163], v[140:143], v[64:79]
    ds_read_b64_tr_b16 v[158:159], v181 offset:29184
    ds_read_b128 v[132:135], v178 offset:36864
    buffer_load_dwordx4 a[12:15], v237, s[48:51], s4 offen offset:2048 sc1
    s_add_u32 s4, s4, 4096
    v_mfma_f32_32x32x16_bf16 v[80:95], v[164:167], v[140:143], v[80:95]
    buffer_load_dwordx4 v183, s[36:39], s72 offen offset:1024  lds
    v_mfma_f32_32x32x16_bf16 v[96:111], v[168:171], v[140:143], v[96:111]
    buffer_load_dwordx4 v184, s[36:39], s72 offen offset:2048  lds
    v_mfma_f32_32x32x16_bf16 v[112:127], v[172:175], v[140:143], v[112:127]
    buffer_load_dwordx4 v185, s[36:39], s72 offen offset:3072  lds
    s_waitcnt lgkmcnt(7)
    v_mfma_f32_32x32x16_bf16 v[0:15], v[144:147], v[128:131], v[0:15]
    ds_read_b128 v[136:139], v179 offset:32768
    ds_read_b64_tr_b16 v[160:161], v180 offset:22528
    s_waitcnt lgkmcnt(7)
    v_mfma_f32_32x32x16_bf16 v[16:31], v[148:151], v[128:131], v[16:31]
    ds_read_b64_tr_b16 v[162:163], v180 offset:23040
    ds_read_b64_tr_b16 v[164:165], v181 offset:22528
    s_waitcnt lgkmcnt(7)
    v_mfma_f32_32x32x16_bf16 v[32:47], v[152:155], v[128:131], v[32:47]
    ds_read_b64_tr_b16 v[166:167], v181 offset:23040
    ds_read_b64_tr_b16 v[168:169], v180 offset:30720
    buffer_load_dwordx4 a[16:19], v236, s[48:51], s4 offen offset:0 sc1
    s_waitcnt lgkmcnt(7)
    v_mfma_f32_32x32x16_bf16 v[48:63], v[156:159], v[128:131], v[48:63]
    ds_read_b64_tr_b16 v[170:171], v180 offset:31232
    ds_read_b64_tr_b16 v[172:173], v181 offset:30720
    buffer_load_dwordx4 a[20:23], v237, s[48:51], s4 offen offset:0 sc1
    s_waitcnt lgkmcnt(8)
    v_mfma_f32_32x32x16_bf16 v[64:79], v[144:147], v[132:135], v[64:79]
    ds_read_b64_tr_b16 v[174:175], v181 offset:31232
    ds_read_b128 v[140:143], v179 offset:36864
    s_add_u32 m0, s74, 4096
    s_nop 0
    buffer_load_dwordx4 v186, s[36:39], s72 offen offset:0  lds
    v_mfma_f32_32x32x16_bf16 v[80:95], v[148:151], v[132:135], v[80:95]
    buffer_load_dwordx4 v187, s[36:39], s72 offen offset:1024  lds
    v_mfma_f32_32x32x16_bf16 v[96:111], v[152:155], v[132:135], v[96:111]
    buffer_load_dwordx4 v188, s[36:39], s72 offen offset:2048  lds
    v_mfma_f32_32x32x16_bf16 v[112:127], v[156:159], v[132:135], v[112:127]
    buffer_load_dwordx4 v189, s[36:39], s72 offen offset:3072  lds
    s_waitcnt lgkmcnt(7)
    v_mfma_f32_32x32x16_bf16 v[0:15], v[160:163], v[136:139], v[0:15]
    s_waitcnt lgkmcnt(5)
    v_mfma_f32_32x32x16_bf16 v[16:31], v[164:167], v[136:139], v[16:31]
    s_waitcnt lgkmcnt(0)
    s_waitcnt vmcnt(18)
    s_barrier
    v_add_u32 v176, 0x10000, v176
    ds_read_b128 v[128:131], v176 offset:0
    ds_read_b64_tr_b16 v[144:145], v180 offset:32768
    v_mfma_f32_32x32x16_bf16 v[32:47], v[168:171], v[136:139], v[32:47]
    ds_read_b64_tr_b16 v[146:147], v180 offset:33280
    ds_read_b64_tr_b16 v[148:149], v181 offset:32768
    v_mfma_f32_32x32x16_bf16 v[48:63], v[172:175], v[136:139], v[48:63]
    ds_read_b64_tr_b16 v[150:151], v181 offset:33280
    ds_read_b64_tr_b16 v[152:153], v180 offset:40960
    v_mfma_f32_32x32x16_bf16 v[64:79], v[160:163], v[140:143], v[64:79]
    ds_read_b64_tr_b16 v[154:155], v180 offset:41472
    ds_read_b64_tr_b16 v[156:157], v181 offset:40960
    buffer_load_dwordx4 a[24:27], v236, s[48:51], s4 offen offset:2048 sc1
    v_mfma_f32_32x32x16_bf16 v[80:95], v[164:167], v[140:143], v[80:95]
    ds_read_b64_tr_b16 v[158:159], v181 offset:41472
    ds_read_b128 v[132:135], v176 offset:4096
    buffer_load_dwordx4 a[28:31], v237, s[48:51], s4 offen offset:2048 sc1
    s_add_u32 s4, s4, 4096
    v_mfma_f32_32x32x16_bf16 v[96:111], v[168:171], v[140:143], v[96:111]
    s_add_u32 s80, s71, 7
    s_and_b32 s80, s80, 7
    s_lshl_b32 s72, s80, 7
    s_mul_i32 s73, s80, 229376
    s_add_u32 m0, s75, 16384
    s_nop 0
    buffer_load_dwordx4 v190, s[40:43], s73 offen offset:0  lds
    v_mfma_f32_32x32x16_bf16 v[112:127], v[172:175], v[140:143], v[112:127]
    buffer_load_dwordx4 v191, s[40:43], s73 offen offset:1024  lds
    s_waitcnt lgkmcnt(7)
    v_mfma_f32_32x32x16_bf16 v[0:15], v[144:147], v[128:131], v[0:15]
    v_add_u32 v177, 0x10000, v177
    ds_read_b128 v[136:139], v177 offset:0
    ds_read_b64_tr_b16 v[160:161], v180 offset:34816
    s_waitcnt lgkmcnt(7)
    v_mfma_f32_32x32x16_bf16 v[16:31], v[148:151], v[128:131], v[16:31]
    ds_read_b64_tr_b16 v[162:163], v180 offset:35328
    ds_read_b64_tr_b16 v[164:165], v181 offset:34816
    s_waitcnt lgkmcnt(7)
    v_mfma_f32_32x32x16_bf16 v[32:47], v[152:155], v[128:131], v[32:47]
    ds_read_b64_tr_b16 v[166:167], v181 offset:35328
    ds_read_b64_tr_b16 v[168:169], v180 offset:43008
    s_waitcnt lgkmcnt(7)
    v_mfma_f32_32x32x16_bf16 v[48:63], v[156:159], v[128:131], v[48:63]
    ds_read_b64_tr_b16 v[170:171], v180 offset:43520
    ds_read_b64_tr_b16 v[172:173], v181 offset:43008
    buffer_load_dwordx4 a[32:35], v236, s[48:51], s4 offen offset:0 sc1
    s_waitcnt lgkmcnt(8)
    v_mfma_f32_32x32x16_bf16 v[64:79], v[144:147], v[132:135], v[64:79]
    ds_read_b64_tr_b16 v[174:175], v181 offset:43520
    ds_read_b128 v[140:143], v177 offset:4096
    buffer_load_dwordx4 a[36:39], v237, s[48:51], s4 offen offset:0 sc1
    v_mfma_f32_32x32x16_bf16 v[80:95], v[148:151], v[132:135], v[80:95]
    s_add_u32 m0, s75, 24576
    s_nop 0
    buffer_load_dwordx4 v190, s[44:47], s73 offen offset:0  lds
    v_mfma_f32_32x32x16_bf16 v[96:111], v[152:155], v[132:135], v[96:111]
    buffer_load_dwordx4 v191, s[44:47], s73 offen offset:1024  lds
    v_mfma_f32_32x32x16_bf16 v[112:127], v[156:159], v[132:135], v[112:127]
    s_add_u32 m0, s74, 32768
    s_nop 0
    buffer_load_dwordx4 v182, s[36:39], s72 offen offset:0  lds
    s_waitcnt lgkmcnt(7)
    v_mfma_f32_32x32x16_bf16 v[0:15], v[160:163], v[136:139], v[0:15]
    v_add_u32 v178, 0x10000, v178
    ds_read_b128 v[128:131], v178 offset:0
    ds_read_b64_tr_b16 v[144:145], v180 offset:36864
    s_waitcnt lgkmcnt(7)
    v_mfma_f32_32x32x16_bf16 v[16:31], v[164:167], v[136:139], v[16:31]
    ds_read_b64_tr_b16 v[146:147], v180 offset:37376
    ds_read_b64_tr_b16 v[148:149], v181 offset:36864
    s_waitcnt lgkmcnt(7)
    v_mfma_f32_32x32x16_bf16 v[32:47], v[168:171], v[136:139], v[32:47]
    ds_read_b64_tr_b16 v[150:151], v181 offset:37376
    ds_read_b64_tr_b16 v[152:153], v180 offset:45056
    buffer_load_dwordx4 a[40:43], v236, s[48:51], s4 offen offset:2048 sc1
    s_waitcnt lgkmcnt(7)
    v_mfma_f32_32x32x16_bf16 v[48:63], v[172:175], v[136:139], v[48:63]
    ds_read_b64_tr_b16 v[154:155], v180 offset:45568
    ds_read_b64_tr_b16 v[156:157], v181 offset:45056
    buffer_load_dwordx4 a[44:47], v237, s[48:51], s4 offen offset:2048 sc1
    s_add_u32 s4, s4, 4096
    s_waitcnt lgkmcnt(8)
    v_mfma_f32_32x32x16_bf16 v[64:79], v[160:163], v[140:143], v[64:79]
    ds_read_b64_tr_b16 v[158:159], v181 offset:45568
    ds_read_b128 v[132:135], v178 offset:4096
    buffer_load_dwordx4 a[48:51], v236, s[48:51], s4 offen offset:0 sc1
    v_mfma_f32_32x32x16_bf16 v[80:95], v[164:167], v[140:143], v[80:95]
    buffer_load_dwordx4 v183, s[36:39], s72 offen offset:1024  lds
    v_mfma_f32_32x32x16_bf16 v[96:111], v[168:171], v[140:143], v[96:111]
    buffer_load_dwordx4 v184, s[36:39], s72 offen offset:2048  lds
    v_mfma_f32_32x32x16_bf16 v[112:127], v[172:175], v[140:143], v[112:127]
    buffer_load_dwordx4 v185, s[36:39], s72 offen offset:3072  lds
    s_waitcnt lgkmcnt(7)
    v_mfma_f32_32x32x16_bf16 v[0:15], v[144:147], v[128:131], v[0:15]
    v_add_u32 v179, 0x10000, v179
    ds_read_b128 v[136:139], v179 offset:0
    ds_read_b64_tr_b16 v[160:161], v180 offset:38912
    s_waitcnt lgkmcnt(7)
    v_mfma_f32_32x32x16_bf16 v[16:31], v[148:151], v[128:131], v[16:31]
    ds_read_b64_tr_b16 v[162:163], v180 offset:39424
    ds_read_b64_tr_b16 v[164:165], v181 offset:38912
    s_waitcnt lgkmcnt(7)
    v_mfma_f32_32x32x16_bf16 v[32:47], v[152:155], v[128:131], v[32:47]
    ds_read_b64_tr_b16 v[166:167], v181 offset:39424
    ds_read_b64_tr_b16 v[168:169], v180 offset:47104
    buffer_load_dwordx4 a[52:55], v237, s[48:51], s4 offen offset:0 sc1
    s_waitcnt lgkmcnt(7)
    v_mfma_f32_32x32x16_bf16 v[48:63], v[156:159], v[128:131], v[48:63]
    ds_read_b64_tr_b16 v[170:171], v180 offset:47616
    ds_read_b64_tr_b16 v[172:173], v181 offset:47104
    buffer_load_dwordx4 a[56:59], v236, s[48:51], s4 offen offset:2048 sc1
    s_waitcnt lgkmcnt(8)
    v_mfma_f32_32x32x16_bf16 v[64:79], v[144:147], v[132:135], v[64:79]
    ds_read_b64_tr_b16 v[174:175], v181 offset:47616
    ds_read_b128 v[140:143], v179 offset:4096
    s_add_u32 m0, s74, 36864
    s_nop 0
    buffer_load_dwordx4 v186, s[36:39], s72 offen offset:0  lds
    v_mfma_f32_32x32x16_bf16 v[80:95], v[148:151], v[132:135], v[80:95]
    buffer_load_dwordx4 v187, s[36:39], s72 offen offset:1024  lds
    v_mfma_f32_32x32x16_bf16 v[96:111], v[152:155], v[132:135], v[96:111]
    buffer_load_dwordx4 v188, s[36:39], s72 offen offset:2048  lds
    v_mfma_f32_32x32x16_bf16 v[112:127], v[156:159], v[132:135], v[112:127]
    buffer_load_dwordx4 v189, s[36:39], s72 offen offset:3072  lds
    s_waitcnt lgkmcnt(7)
    v_mfma_f32_32x32x16_bf16 v[0:15], v[160:163], v[136:139], v[0:15]
    s_waitcnt lgkmcnt(5)
    v_mfma_f32_32x32x16_bf16 v[16:31], v[164:167], v[136:139], v[16:31]
    s_waitcnt lgkmcnt(0)
    s_waitcnt vmcnt(21)
    s_barrier
    v_subrev_u32 v176, 0x10000, v176
    ds_read_b128 v[128:131], v176 offset:0
    ds_read_b64_tr_b16 v[144:145], v180 offset:0
    s_mov_b64 exec, s[14:15]
    buffer_load_dwordx2 v[244:245], v241, s[48:51], 0 offen sc1
    s_mov_b64 exec, -1
    v_mfma_f32_32x32x16_bf16 v[32:47], v[168:171], v[136:139], v[32:47]
    ds_read_b64_tr_b16 v[146:147], v180 offset:512
    ds_read_b64_tr_b16 v[148:149], v181 offset:0
    v_mfma_f32_32x32x16_bf16 v[48:63], v[172:175], v[136:139], v[48:63]
    ds_read_b64_tr_b16 v[150:151], v181 offset:512
    ds_read_b64_tr_b16 v[152:153], v180 offset:8192
    v_mfma_f32_32x32x16_bf16 v[64:79], v[160:163], v[140:143], v[64:79]
    ds_read_b64_tr_b16 v[154:155], v180 offset:8704
    ds_read_b64_tr_b16 v[156:157], v181 offset:8192
    v_mfma_f32_32x32x16_bf16 v[80:95], v[164:167], v[140:143], v[80:95]
    ds_read_b64_tr_b16 v[158:159], v181 offset:8704
    ds_read_b128 v[132:135], v176 offset:4096
    buffer_load_dwordx4 a[60:63], v237, s[48:51], s4 offen offset:2048 sc1
    s_add_u32 s4, s4, 4096
    v_mfma_f32_32x32x16_bf16 v[96:111], v[168:171], v[140:143], v[96:111]
    buffer_load_dwordx4 a[64:67], v236, s[48:51], s4 offen offset:0 sc1
    v_mfma_f32_32x32x16_bf16 v[112:127], v[172:175], v[140:143], v[112:127]
    buffer_load_dwordx4 a[68:71], v237, s[48:51], s4 offen offset:0 sc1
    s_waitcnt lgkmcnt(7)
    v_mfma_f32_32x32x16_bf16 v[0:15], v[144:147], v[128:131], v[0:15]
    v_subrev_u32 v177, 0x10000, v177
    ds_read_b128 v[136:139], v177 offset:0
    ds_read_b64_tr_b16 v[160:161], v180 offset:2048
    v_mov_b32 v196, 0
    v_mov_b32 v197, 0
    v_mov_b32 v198, 0
    v_mov_b32 v199, 0
    s_waitcnt lgkmcnt(7)
    v_mfma_f32_32x32x16_bf16 v[16:31], v[148:151], v[128:131], v[16:31]
    ds_read_b64_tr_b16 v[162:163], v180 offset:2560
    ds_read_b64_tr_b16 v[164:165], v181 offset:2048
    ds_write_b128 v222, v[196:199]
    s_waitcnt lgkmcnt(8)
    v_mfma_f32_32x32x16_bf16 v[32:47], v[152:155], v[128:131], v[32:47]
    ds_read_b64_tr_b16 v[166:167], v181 offset:2560
    ds_read_b64_tr_b16 v[168:169], v180 offset:10240
    s_lshr_b32 s80, s66, 1
    s_mul_i32 s80, s80, 8320
    s_and_b32 s81, s66, 1
    s_lshl_b32 s81, s81, 11
    s_add_u32 s80, s80, s81
    s_add_u32 s80, s80, 131072
    v_lshl_add_u32 v200, v255, 5, s80
    ds_read_u16 v210, v210
    s_waitcnt lgkmcnt(9)
    v_mfma_f32_32x32x16_bf16 v[48:63], v[156:159], v[128:131], v[48:63]
    ds_read_b64_tr_b16 v[170:171], v180 offset:10752
    ds_read_b64_tr_b16 v[172:173], v181 offset:10240
    ds_read_u16 v202, v202
    s_waitcnt lgkmcnt(11)
    v_mfma_f32_32x32x16_bf16 v[64:79], v[144:147], v[132:135], v[64:79]
    ds_read_b64_tr_b16 v[174:175], v181 offset:10752
    ds_read_b128 v[140:143], v177 offset:4096
    ds_read_u16 v211, v211
    ds_read_u16 v203, v203
    v_mfma_f32_32x32x16_bf16 v[80:95], v[148:151], v[132:135], v[80:95]
    buffer_load_dwordx4 a[72:75], v236, s[48:51], s4 offen offset:2048 sc1
    ds_read_u16 v212, v212
    v_mfma_f32_32x32x16_bf16 v[96:111], v[152:155], v[132:135], v[96:111]
    buffer_load_dwordx4 a[76:79], v237, s[48:51], s4 offen offset:2048 sc1
    s_add_u32 s4, s4, 4096
    ds_read_u16 v204, v204
    ds_read_u16 v213, v213
    v_mfma_f32_32x32x16_bf16 v[112:127], v[156:159], v[132:135], v[112:127]
    buffer_load_dwordx4 a[80:83], v236, s[48:51], s4 offen offset:0 sc1
    ds_read_u16 v205, v205
    s_waitcnt lgkmcnt(15)
    v_mfma_f32_32x32x16_bf16 v[0:15], v[160:163], v[136:139], v[0:15]
    v_subrev_u32 v178, 0x10000, v178
    ds_read_b128 v[128:131], v178 offset:0
    ds_read_b64_tr_b16 v[144:145], v180 offset:4096
    ds_read_u16 v214, v214
    ds_read_u16 v206, v206
    s_waitcnt lgkmcnt(15)
    v_mfma_f32_32x32x16_bf16 v[16:31], v[164:167], v[136:139], v[16:31]
    ds_read_b64_tr_b16 v[146:147], v180 offset:4608
    ds_read_b64_tr_b16 v[148:149], v181 offset:4096
    ds_read_u16 v215, v215
    s_waitcnt lgkmcnt(15)
    v_mfma_f32_32x32x16_bf16 v[32:47], v[168:171], v[136:139], v[32:47]
    ds_read_b64_tr_b16 v[150:151], v181 offset:4608
    ds_read_b64_tr_b16 v[152:153], v180 offset:12288
    ds_read_u16 v207, v207
    s_waitcnt lgkmcnt(15)
    v_mfma_f32_32x32x16_bf16 v[48:63], v[172:175], v[136:139], v[48:63]
    ds_read_b64_tr_b16 v[154:155], v180 offset:12800
    ds_read_b64_tr_b16 v[156:157], v181 offset:12288
    ds_read_u16 v216, v216
    v_mfma_f32_32x32x16_bf16 v[64:79], v[160:163], v[140:143], v[64:79]
    ds_read_b64_tr_b16 v[158:159], v181 offset:12800
    ds_read_b128 v[132:135], v178 offset:4096
    ds_read_u16 v208, v208
    v_mfma_f32_32x32x16_bf16 v[80:95], v[164:167], v[140:143], v[80:95]
    buffer_load_dwordx4 a[84:87], v237, s[48:51], s4 offen offset:0 sc1
    ds_read_u16 v217, v217
    v_mfma_f32_32x32x16_bf16 v[96:111], v[168:171], v[140:143], v[96:111]
    buffer_load_dwordx4 a[88:91], v236, s[48:51], s4 offen offset:2048 sc1
    ds_read_u16 v209, v209
    v_mfma_f32_32x32x16_bf16 v[112:127], v[172:175], v[140:143], v[112:127]
    buffer_load_dwordx4 a[92:95], v237, s[48:51], s4 offen offset:2048 sc1
    s_add_u32 s4, s4, 4096
    ds_read_u16 v218, v218
    s_waitcnt lgkmcnt(14)
    v_mfma_f32_32x32x16_bf16 v[0:15], v[144:147], v[128:131], v[0:15]
    v_subrev_u32 v179, 0x10000, v179
    ds_read_b128 v[136:139], v179 offset:0
    ds_read_b64_tr_b16 v[160:161], v180 offset:6144
    v_lshl_or_b32 v192, v202, 16, v210
    v_lshl_or_b32 v202, v211, 16, v202
    s_waitcnt lgkmcnt(13)
    v_mfma_f32_32x32x16_bf16 v[16:31], v[148:151], v[128:131], v[16:31]
    ds_read_b64_tr_b16 v[162:163], v180 offset:6656
    ds_read_b64_tr_b16 v[164:165], v181 offset:6144
    v_lshl_or_b32 v193, v203, 16, v211
    v_lshl_or_b32 v203, v212, 16, v203
    s_waitcnt lgkmcnt(12)
    v_mfma_f32_32x32x16_bf16 v[32:47], v[152:155], v[128:131], v[32:47]
    ds_read_b64_tr_b16 v[166:167], v181 offset:6656
    ds_read_b64_tr_b16 v[168:169], v180 offset:14336
    v_lshl_or_b32 v194, v204, 16, v212
    v_lshl_or_b32 v204, v213, 16, v204
    s_waitcnt lgkmcnt(11)
    v_mfma_f32_32x32x16_bf16 v[48:63], v[156:159], v[128:131], v[48:63]
    ds_read_b64_tr_b16 v[170:171], v180 offset:14848
    ds_read_b64_tr_b16 v[172:173], v181 offset:14336
    s_waitcnt lgkmcnt(12)
    v_mfma_f32_32x32x16_bf16 v[64:79], v[144:147], v[132:135], v[64:79]
    ds_read_b64_tr_b16 v[174:175], v181 offset:14848
    ds_read_b128 v[140:143], v179 offset:4096
    v_lshl_or_b32 v195, v205, 16, v213
    v_lshl_or_b32 v205, v214, 16, v205
    v_mfma_f32_32x32x16_bf16 v[80:95], v[148:151], v[132:135], v[80:95]
    buffer_load_dwordx4 a[96:99], v236, s[48:51], s4 offen offset:0 sc1
    ds_write_b128 v200, v[192:195] offset:0
    v_mfma_f32_32x32x16_bf16 v[96:111], v[152:155], v[132:135], v[96:111]
    buffer_load_dwordx4 a[100:103], v237, s[48:51], s4 offen offset:0 sc1
    ds_write_b128 v200, v[202:205] offset:4160
    v_mfma_f32_32x32x16_bf16 v[112:127], v[156:159], v[132:135], v[112:127]
    buffer_load_dwordx4 a[104:107], v236, s[48:51], s4 offen offset:2048 sc1
    s_waitcnt lgkmcnt(9)
    v_mfma_f32_32x32x16_bf16 v[0:15], v[160:163], v[136:139], v[0:15]
    v_lshl_or_b32 v196, v206, 16, v214
    v_lshl_or_b32 v206, v215, 16, v206
    s_waitcnt lgkmcnt(7)
    v_mfma_f32_32x32x16_bf16 v[16:31], v[164:167], v[136:139], v[16:31]
    s_mov_b64 exec, s[14:15]
    s_waitcnt vmcnt(12)
    v_and_b32 v244, v244, v245
    v_cmp_ne_u32 vcc, 1, v244
    s_mov_b64 exec, -1
    s_nop 3
    s_cbranch_vccnz L_slow_10
L_ret_11:
    s_waitcnt lgkmcnt(0)
    s_barrier
    ds_read_b128 v[128:131], v176 offset:32768
    ds_read_b64_tr_b16 v[144:145], v180 offset:16384
    s_lshr_b32 s80, s77, 1
    s_lshl_b32 s80, s80, 14
    s_and_b32 s81, s77, 1
    s_lshl_b32 s81, s81, 5
    s_add_u32 s80, s80, s81
    s_lshl_b32 s81, s66, 11
    s_add_u32 s80, s80, s81
    s_add_u32 s80, s80, 3145728
    s_add_u32 s81, s80, 8192
    v_lshrrev_b32 v232, 1, v255
    v_and_b32 v233, 1, v255
    v_lshlrev_b32 v233, 4, v233
    v_lshl_add_u32 v232, v232, 6, v233
    buffer_load_dwordx4 v[224:227], v232, s[48:51], s80 offen sc1
    buffer_load_dwordx4 v[228:231], v232, s[48:51], s81 offen sc1
    v_lshl_or_b32 v197, v207, 16, v215
    v_lshl_or_b32 v207, v216, 16, v207
    v_mfma_f32_32x32x16_bf16 v[32:47], v[168:171], v[136:139], v[32:47]
    ds_read_b64_tr_b16 v[146:147], v180 offset:16896
    ds_read_b64_tr_b16 v[148:149], v180 offset:24576
    v_lshl_or_b32 v198, v208, 16, v216
    v_lshl_or_b32 v208, v217, 16, v208
    v_mfma_f32_32x32x16_bf16 v[48:63], v[172:175], v[136:139], v[48:63]
    ds_read_b64_tr_b16 v[150:151], v180 offset:25088
    ds_read_b128 v[132:135], v176 offset:36864
    v_mfma_f32_32x32x16_bf16 v[64:79], v[160:163], v[140:143], v[64:79]
    ds_read_b128 v[182:185], v177 offset:32768
    ds_read_b64_tr_b16 v[152:153], v180 offset:18432
    v_lshl_or_b32 v199, v209, 16, v217
    v_lshl_or_b32 v209, v218, 16, v209
    v_mfma_f32_32x32x16_bf16 v[80:95], v[164:167], v[140:143], v[80:95]
    ds_read_b64_tr_b16 v[154:155], v180 offset:18944
    ds_read_b64_tr_b16 v[156:157], v180 offset:26624
    buffer_load_dwordx4 a[108:111], v237, s[48:51], s4 offen offset:2048 sc1
    s_add_u32 s4, s4, 4096
    ds_write_b128 v200, v[196:199] offset:16
    v_mfma_f32_32x32x16_bf16 v[96:111], v[168:171], v[140:143], v[96:111]
    ds_read_b64_tr_b16 v[158:159], v180 offset:27136
    ds_read_b128 v[186:189], v177 offset:36864
    buffer_load_dwordx4 a[112:115], v236, s[48:51], s4 offen offset:0 sc1
    ds_write_b128 v200, v[206:209] offset:4176
    v_mfma_f32_32x32x16_bf16 v[112:127], v[172:175], v[140:143], v[112:127]
    buffer_load_dwordx4 a[116:119], v237, s[48:51], s4 offen offset:0 sc1
    s_waitcnt lgkmcnt(11)
    v_mfma_f32_32x32x16_bf16 v[0:15], v[144:147], v[128:131], v[0:15]
    ds_read_b128 v[136:139], v178 offset:32768
    ds_read_b64_tr_b16 v[160:161], v180 offset:20480
    s_waitcnt lgkmcnt(11)
    v_mfma_f32_32x32x16_bf16 v[32:47], v[148:151], v[128:131], v[32:47]
    ds_read_b64_tr_b16 v[162:163], v180 offset:20992
    ds_read_b64_tr_b16 v[164:165], v180 offset:28672
    s_waitcnt lgkmcnt(12)
    v_mfma_f32_32x32x16_bf16 v[64:79], v[144:147], v[132:135], v[64:79]
    ds_read_b64_tr_b16 v[166:167], v180 offset:29184
    ds_read_b128 v[140:143], v178 offset:36864
    v_mfma_f32_32x32x16_bf16 v[96:111], v[148:151], v[132:135], v[96:111]
    ds_read_b128 v[192:195], v179 offset:32768
    ds_read_b64_tr_b16 v[168:169], v180 offset:22528
    s_waitcnt lgkmcnt(13)
    v_mfma_f32_32x32x16_bf16 v[0:15], v[152:155], v[182:185], v[0:15]
    ds_read_b64_tr_b16 v[170:171], v180 offset:23040
    ds_read_b64_tr_b16 v[172:173], v180 offset:30720
    s_waitcnt lgkmcnt(12)
    v_mfma_f32_32x32x16_bf16 v[32:47], v[156:159], v[182:185], v[32:47]
    ds_read_b64_tr_b16 v[174:175], v180 offset:31232
    ds_read_b128 v[196:199], v179 offset:36864
    buffer_load_dwordx4 a[120:123], v236, s[48:51], s4 offen offset:2048 sc1
    s_waitcnt lgkmcnt(13)
    v_mfma_f32_32x32x16_bf16 v[64:79], v[152:155], v[186:189], v[64:79]
    buffer_load_dwordx4 a[124:127], v237, s[48:51], s4 offen offset:2048 sc1
    s_add_u32 s4, s4, 4096
    v_mfma_f32_32x32x16_bf16 v[96:111], v[156:159], v[186:189], v[96:111]
    buffer_load_dwordx4 a[128:131], v236, s[48:51], s4 offen offset:0 sc1
    s_waitcnt lgkmcnt(9)
    v_mfma_f32_32x32x16_bf16 v[0:15], v[160:163], v[136:139], v[0:15]
    ds_read_b128 v[128:131], v176 offset:32768
    ds_read_b64_tr_b16 v[144:145], v181 offset:16384
    s_lshl_b32 s19, s67, 2
    s_add_u32 s19, s19, s66
    s_lshl_b32 s19, s19, 10
    s_lshl_b32 s18, s68, 18
    s_add_u32 s19, s19, s18
    s_add_u32 s19, s19, 6291456
    v_lshlrev_b32 v201, 4, v255
    s_waitcnt lgkmcnt(9)
    v_mfma_f32_32x32x16_bf16 v[32:47], v[164:167], v[136:139], v[32:47]
    ds_read_b64_tr_b16 v[146:147], v181 offset:16896
    ds_read_b64_tr_b16 v[148:149], v181 offset:24576
    s_waitcnt lgkmcnt(10)
    v_mfma_f32_32x32x16_bf16 v[64:79], v[160:163], v[140:143], v[64:79]
    ds_read_b64_tr_b16 v[150:151], v181 offset:25088
    ds_read_b128 v[132:135], v176 offset:36864
    v_mfma_f32_32x32x16_bf16 v[96:111], v[164:167], v[140:143], v[96:111]
    ds_read_b128 v[182:185], v177 offset:32768
    ds_read_b64_tr_b16 v[152:153], v181 offset:18432
    s_waitcnt lgkmcnt(11)
    v_mfma_f32_32x32x16_bf16 v[0:15], v[168:171], v[192:195], v[0:15]
    ds_read_b64_tr_b16 v[154:155], v181 offset:18944
    ds_read_b64_tr_b16 v[156:157], v181 offset:26624
    s_waitcnt lgkmcnt(11)
    v_mfma_f32_32x32x16_bf16 v[32:47], v[172:175], v[192:195], v[32:47]
    ds_read_b64_tr_b16 v[158:159], v181 offset:27136
    ds_read_b128 v[186:189], v177 offset:36864
    buffer_load_dwordx4 a[132:135], v237, s[48:51], s4 offen offset:0 sc1
    s_waitcnt lgkmcnt(12)
    v_mfma_f32_32x32x16_bf16 v[64:79], v[168:171], v[196:199], v[64:79]
    buffer_load_dwordx4 a[136:139], v236, s[48:51], s4 offen offset:2048 sc1
    v_mfma_f32_32x32x16_bf16 v[96:111], v[172:175], v[196:199], v[96:111]
    buffer_load_dwordx4 a[140:143], v237, s[48:51], s4 offen offset:2048 sc1
    s_add_u32 s4, s4, 4096
    s_waitcnt lgkmcnt(9)
    v_mfma_f32_32x32x16_bf16 v[16:31], v[144:147], v[128:131], v[16:31]
    ds_read_b128 v[136:139], v178 offset:32768
    ds_read_b64_tr_b16 v[160:161], v181 offset:20480
    s_lshl_b32 s80, s66, 9
    s_add_u32 s80, s80, 148224
    v_lshrrev_b32 v232, 1, v255
    v_and_b32 v233, 1, v255
    v_mul_u32_u24 v233, 4672, v233
    v_lshl_add_u32 v232, v232, 4, v233
    v_add_u32 v232, s80, v232
    s_waitcnt vmcnt(10)
    ds_write_b128 v232, v[224:227]
    s_waitcnt vmcnt(9)
    ds_write_b128 v232, v[228:231] offset:2048
    s_waitcnt lgkmcnt(11)
    v_mfma_f32_32x32x16_bf16 v[48:63], v[148:151], v[128:131], v[48:63]
    ds_read_b64_tr_b16 v[162:163], v181 offset:20992
    ds_read_b64_tr_b16 v[164:165], v181 offset:28672
    v_max_f32 v0, 0, v0
    v_max_f32 v1, 0, v1
    v_max_f32 v2, 0, v2
    v_max_f32 v3, 0, v3
    v_mul_f32 v0, v0, v32
    s_waitcnt lgkmcnt(12)
    v_mfma_f32_32x32x16_bf16 v[80:95], v[144:147], v[132:135], v[80:95]
    ds_read_b64_tr_b16 v[166:167], v181 offset:29184
    ds_read_b128 v[140:143], v178 offset:36864
    v_mul_f32 v1, v1, v33
    v_mul_f32 v2, v2, v34
    v_mul_f32 v3, v3, v35
    v_max_f32 v64, 0, v64
    v_max_f32 v65, 0, v65
    v_max_f32 v66, 0, v66
    v_max_f32 v67, 0, v67
    v_mfma_f32_32x32x16_bf16 v[112:127], v[148:151], v[132:135], v[112:127]
    ds_read_b128 v[192:195], v179 offset:32768
    ds_read_b64_tr_b16 v[168:169], v181 offset:22528
    v_mul_f32 v64, v64, v96
    v_mul_f32 v65, v65, v97
    v_mul_f32 v66, v66, v98
    v_mul_f32 v67, v67, v99
    v_cvt_pk_bf16_f32 v0, v0, v1
    v_cvt_pk_bf16_f32 v1, v2, v3
    s_waitcnt lgkmcnt(13)
    v_mfma_f32_32x32x16_bf16 v[16:31], v[152:155], v[182:185], v[16:31]
    ds_read_b64_tr_b16 v[170:171], v181 offset:23040
    ds_read_b64_tr_b16 v[172:173], v181 offset:30720
    v_cvt_pk_bf16_f32 v2, v64, v65
    v_cvt_pk_bf16_f32 v3, v66, v67
    v_max_f32 v4, 0, v4
    v_max_f32 v5, 0, v5
    v_permlane32_swap_b32 v0, v2
    v_permlane32_swap_b32 v1, v3
    buffer_store_dwordx4 v[0:3], v201, s[48:51], s19 offen sc1
    s_add_u32 s19, s19, 32768
    s_waitcnt lgkmcnt(13)
    v_mfma_f32_32x32x16_bf16 v[48:63], v[156:159], v[182:185], v[48:63]
    ds_read_b64_tr_b16 v[174:175], v181 offset:31232
    ds_read_b128 v[196:199], v179 offset:36864
    v_max_f32 v6, 0, v6
    v_max_f32 v7, 0, v7
    v_mul_f32 v4, v4, v36
    v_mul_f32 v5, v5, v37
    v_mul_f32 v6, v6, v38
    v_mul_f32 v7, v7, v39
    s_waitcnt lgkmcnt(14)
    v_mfma_f32_32x32x16_bf16 v[80:95], v[152:155], v[186:189], v[80:95]
    v_max_f32 v68, 0, v68
    v_max_f32 v69, 0, v69
    v_max_f32 v70, 0, v70
    v_max_f32 v71, 0, v71
    v_mul_f32 v68, v68, v100
    v_mul_f32 v69, v69, v101
    v_mul_f32 v70, v70, v102
    v_mfma_f32_32x32x16_bf16 v[112:127], v[156:159], v[186:189], v[112:127]
    v_mul_f32 v71, v71, v103
    v_cvt_pk_bf16_f32 v4, v4, v5
    v_cvt_pk_bf16_f32 v5, v6, v7
    v_cvt_pk_bf16_f32 v6, v68, v69
    v_cvt_pk_bf16_f32 v7, v70, v71
    v_max_f32 v8, 0, v8
    s_waitcnt lgkmcnt(9)
    v_mfma_f32_32x32x16_bf16 v[16:31], v[160:163], v[136:139], v[16:31]
    v_max_f32 v9, 0, v9
    v_permlane32_swap_b32 v4, v6
    v_permlane32_swap_b32 v5, v7
    buffer_store_dwordx4 v[4:7], v201, s[48:51], s19 offen sc1
    s_add_u32 s19, s19, 32768
    v_max_f32 v10, 0, v10
    v_max_f32 v11, 0, v11
    s_waitcnt lgkmcnt(7)
    v_mfma_f32_32x32x16_bf16 v[48:63], v[164:167], v[136:139], v[48:63]
    s_waitcnt lgkmcnt(0)
    s_barrier
    v_mul_f32 v8, v8, v40
    v_mul_f32 v9, v9, v41
    v_mul_f32 v10, v10, v42
    v_mul_f32 v11, v11, v43
    v_max_f32 v72, 0, v72
    v_max_f32 v73, 0, v73
    v_mfma_f32_32x32x16_bf16 v[80:95], v[160:163], v[140:143], v[80:95]
    v_max_f32 v74, 0, v74
    v_max_f32 v75, 0, v75
    v_mul_f32 v72, v72, v104
    v_mul_f32 v73, v73, v105
    v_mul_f32 v74, v74, v106
    v_mul_f32 v75, v75, v107
    v_mfma_f32_32x32x16_bf16 v[112:127], v[164:167], v[140:143], v[112:127]
    v_cvt_pk_bf16_f32 v8, v8, v9
    v_cvt_pk_bf16_f32 v9, v10, v11
    v_cvt_pk_bf16_f32 v10, v72, v73
    v_cvt_pk_bf16_f32 v11, v74, v75
    v_max_f32 v12, 0, v12
    v_max_f32 v13, 0, v13
    v_mfma_f32_32x32x16_bf16 v[16:31], v[168:171], v[192:195], v[16:31]
    v_permlane32_swap_b32 v8, v10
    v_permlane32_swap_b32 v9, v11
    buffer_store_dwordx4 v[8:11], v201, s[48:51], s19 offen sc1
    s_add_u32 s19, s19, 32768
    v_max_f32 v14, 0, v14
    v_max_f32 v15, 0, v15
    v_mul_f32 v12, v12, v44
    v_mfma_f32_32x32x16_bf16 v[48:63], v[172:175], v[192:195], v[48:63]
    v_mul_f32 v13, v13, v45
    v_mul_f32 v14, v14, v46
    v_mul_f32 v15, v15, v47
    v_max_f32 v76, 0, v76
    v_max_f32 v77, 0, v77
    v_max_f32 v78, 0, v78
    v_mfma_f32_32x32x16_bf16 v[80:95], v[168:171], v[196:199], v[80:95]
    v_max_f32 v79, 0, v79
    v_mul_f32 v76, v76, v108
    v_mul_f32 v77, v77, v109
    v_mul_f32 v78, v78, v110
    v_mul_f32 v79, v79, v111
    v_cvt_pk_bf16_f32 v12, v12, v13
    v_mfma_f32_32x32x16_bf16 v[112:127], v[172:175], v[196:199], v[112:127]
    v_cvt_pk_bf16_f32 v13, v14, v15
    v_cvt_pk_bf16_f32 v14, v76, v77
    v_cvt_pk_bf16_f32 v15, v78, v79
    s_nop 0
    v_permlane32_swap_b32 v12, v14
    v_permlane32_swap_b32 v13, v15
    buffer_store_dwordx4 v[12:15], v201, s[48:51], s19 offen sc1
    s_add_u32 s19, s19, 32768
    ds_read2_b32 v[32:33], v248 offset0:176 offset1:177
    ds_read2_b32 v[34:35], v248 offset0:178 offset1:179
    ds_read_b128 v[64:67], v252 offset:192
    ds_read_b128 v[68:71], v252 offset:704
    ds_read_b128 v[72:75], v252 offset:1216
    ds_read_b128 v[76:79], v252 offset:1728
    ds_read2_b32 v[36:37], v248 offset0:48 offset1:49
    ds_read2_b32 v[38:39], v248 offset0:50 offset1:51
    v_max_f32 v16, 0, v16
    v_max_f32 v17, 0, v17
    v_max_f32 v18, 0, v18
    v_max_f32 v19, 0, v19
    v_pk_mul_f32 v[16:17], v[16:17], v[48:49]
    v_pk_mul_f32 v[18:19], v[18:19], v[50:51]
    v_max_f32 v80, 0, v80
    v_max_f32 v81, 0, v81
    v_max_f32 v82, 0, v82
    v_max_f32 v83, 0, v83
    v_pk_mul_f32 v[80:81], v[80:81], v[112:113]
    v_pk_mul_f32 v[82:83], v[82:83], v[114:115]
    v_cvt_pk_bf16_f32 v16, v16, v17
    v_cvt_pk_bf16_f32 v17, v18, v19
    v_cvt_pk_bf16_f32 v18, v80, v81
    v_cvt_pk_bf16_f32 v19, v82, v83
    ds_read_b128 v[80:83], v252 offset:2240
    v_max_f32 v20, 0, v20
    v_max_f32 v21, 0, v21
    v_permlane32_swap_b32 v16, v18
    v_permlane32_swap_b32 v17, v19
    buffer_store_dwordx4 v[16:19], v201, s[48:51], s19 offen sc1
    s_add_u32 s19, s19, 32768
    v_max_f32 v22, 0, v22
    v_max_f32 v23, 0, v23
    v_pk_mul_f32 v[20:21], v[20:21], v[52:53]
    v_pk_mul_f32 v[22:23], v[22:23], v[54:55]
    v_max_f32 v84, 0, v84
    v_max_f32 v85, 0, v85
    v_max_f32 v86, 0, v86
    v_max_f32 v87, 0, v87
    v_pk_mul_f32 v[84:85], v[84:85], v[116:117]
    v_pk_mul_f32 v[86:87], v[86:87], v[118:119]
    v_cvt_pk_bf16_f32 v20, v20, v21
    v_cvt_pk_bf16_f32 v21, v22, v23
    v_cvt_pk_bf16_f32 v22, v84, v85
    v_cvt_pk_bf16_f32 v23, v86, v87
    ds_read_b128 v[84:87], v252 offset:2752
    v_max_f32 v24, 0, v24
    v_max_f32 v25, 0, v25
    v_permlane32_swap_b32 v20, v22
    v_permlane32_swap_b32 v21, v23
    buffer_store_dwordx4 v[20:23], v201, s[48:51], s19 offen sc1
    s_add_u32 s19, s19, 32768
    v_max_f32 v26, 0, v26
    v_max_f32 v27, 0, v27
    v_pk_mul_f32 v[24:25], v[24:25], v[56:57]
    v_pk_mul_f32 v[26:27], v[26:27], v[58:59]
    v_max_f32 v88, 0, v88
    v_max_f32 v89, 0, v89
    v_max_f32 v90, 0, v90
    v_max_f32 v91, 0, v91
    v_pk_mul_f32 v[88:89], v[88:89], v[120:121]
    v_pk_mul_f32 v[90:91], v[90:91], v[122:123]
    v_cvt_pk_bf16_f32 v24, v24, v25
    v_cvt_pk_bf16_f32 v25, v26, v27
    v_cvt_pk_bf16_f32 v26, v88, v89
    v_cvt_pk_bf16_f32 v27, v90, v91
    ds_read_b128 v[88:91], v252 offset:3264
    v_max_f32 v28, 0, v28
    v_max_f32 v29, 0, v29
    v_permlane32_swap_b32 v24, v26
    v_permlane32_swap_b32 v25, v27
    buffer_store_dwordx4 v[24:27], v201, s[48:51], s19 offen sc1
    s_add_u32 s19, s19, 32768
    v_max_f32 v30, 0, v30
    v_max_f32 v31, 0, v31
    v_pk_mul_f32 v[28:29], v[28:29], v[60:61]
    v_pk_mul_f32 v[30:31], v[30:31], v[62:63]
    v_max_f32 v92, 0, v92
    v_max_f32 v93, 0, v93
    v_max_f32 v94, 0, v94
    v_max_f32 v95, 0, v95
    v_pk_mul_f32 v[92:93], v[92:93], v[124:125]
    v_pk_mul_f32 v[94:95], v[94:95], v[126:127]
    v_cvt_pk_bf16_f32 v28, v28, v29
    v_cvt_pk_bf16_f32 v29, v30, v31
    v_cvt_pk_bf16_f32 v30, v92, v93
    v_cvt_pk_bf16_f32 v31, v94, v95
    ds_read_b128 v[92:95], v252 offset:3776
    v_permlane32_swap_b32 v28, v30
    v_permlane32_swap_b32 v29, v31
    buffer_store_dwordx4 v[28:31], v201, s[48:51], s19 offen sc1
L_tail_3:
    s_waitcnt lgkmcnt(9)
    v_mfma_f32_16x16x32_bf16 v[0:3], v[32:35], v[64:67], 0
    ds_read2_b32 v[40:41], v249 offset0:176 offset1:177
    s_waitcnt lgkmcnt(9)
    v_mfma_f32_16x16x32_bf16 v[4:7], v[32:35], v[68:71], 0
    ds_read2_b32 v[42:43], v249 offset0:178 offset1:179
    s_waitcnt lgkmcnt(9)
    v_mfma_f32_16x16x32_bf16 v[8:11], v[32:35], v[72:75], 0
    ds_read2_b32 v[44:45], v249 offset0:48 offset1:49
    s_waitcnt lgkmcnt(9)
    v_mfma_f32_16x16x32_bf16 v[12:15], v[32:35], v[76:79], 0
    ds_read2_b32 v[46:47], v249 offset0:50 offset1:51
    s_waitcnt lgkmcnt(7)
    v_mfma_f32_16x16x32_bf16 v[16:19], v[32:35], v[80:83], 0
    ds_read2_b32 v[48:49], v250 offset0:176 offset1:177
    s_waitcnt lgkmcnt(7)
    v_mfma_f32_16x16x32_bf16 v[20:23], v[32:35], v[84:87], 0
    ds_read2_b32 v[50:51], v250 offset0:178 offset1:179
    s_waitcnt lgkmcnt(7)
    v_mfma_f32_16x16x32_bf16 v[24:27], v[32:35], v[88:91], 0
    ds_read2_b32 v[52:53], v250 offset0:48 offset1:49
    s_waitcnt lgkmcnt(7)
    v_mfma_f32_16x16x32_bf16 v[28:31], v[32:35], v[92:95], 0
    ds_read2_b32 v[54:55], v250 offset0:50 offset1:51
    v_mfma_f32_16x16x32_bf16 v[4:7], v[36:39], v[64:67], v[4:7]
    ds_read2_b32 v[56:57], v251 offset0:176 offset1:177
    v_mfma_f32_16x16x32_bf16 v[8:11], v[36:39], v[68:71], v[8:11]
    ds_read2_b32 v[58:59], v251 offset0:178 offset1:179
    v_mfma_f32_16x16x32_bf16 v[12:15], v[36:39], v[72:75], v[12:15]
    ds_read2_b32 v[60:61], v251 offset0:48 offset1:49
    v_mfma_f32_16x16x32_bf16 v[16:19], v[36:39], v[76:79], v[16:19]
    ds_read2_b32 v[62:63], v251 offset0:50 offset1:51
    v_mfma_f32_16x16x32_bf16 v[20:23], v[36:39], v[80:83], v[20:23]
    ds_read2_b32 v[96:97], v248 offset0:160 offset1:161
    v_mfma_f32_16x16x32_bf16 v[24:27], v[36:39], v[84:87], v[24:27]
    ds_read2_b32 v[98:99], v248 offset0:162 offset1:163
    v_mfma_f32_16x16x32_bf16 v[28:31], v[36:39], v[88:91], v[28:31]
    ds_read_b128 v[128:131], v252 offset:128
    s_waitcnt lgkmcnt(13)
    v_mfma_f32_16x16x32_bf16 v[8:11], v[40:43], v[64:67], v[8:11]
    ds_read_b128 v[132:135], v252 offset:640
    v_mfma_f32_16x16x32_bf16 v[12:15], v[40:43], v[68:71], v[12:15]
    ds_read_b128 v[136:139], v252 offset:1152
    ds_read_b128 v[140:143], v252 offset:1664
    v_mfma_f32_16x16x32_bf16 v[16:19], v[40:43], v[72:75], v[16:19]
    ds_read_b128 v[144:147], v252 offset:2176
    v_mfma_f32_16x16x32_bf16 v[20:23], v[40:43], v[76:79], v[20:23]
    ds_read_b128 v[148:151], v252 offset:2688
    v_mfma_f32_16x16x32_bf16 v[24:27], v[40:43], v[80:83], v[24:27]
    ds_read_b128 v[152:155], v252 offset:3200
    v_mfma_f32_16x16x32_bf16 v[28:31], v[40:43], v[84:87], v[28:31]
    ds_read_b128 v[156:159], v252 offset:3712
    s_waitcnt lgkmcnt(15)
    v_mfma_f32_16x16x32_bf16 v[12:15], v[44:47], v[64:67], v[12:15]
    ds_read2_b32 v[100:101], v248 offset0:32 offset1:33
    v_mfma_f32_16x16x32_bf16 v[16:19], v[44:47], v[68:71], v[16:19]
    ds_read2_b32 v[102:103], v248 offset0:34 offset1:35
    v_mfma_f32_16x16x32_bf16 v[20:23], v[44:47], v[72:75], v[20:23]
    ds_read2_b32 v[104:105], v249 offset0:160 offset1:161
    v_mfma_f32_16x16x32_bf16 v[24:27], v[44:47], v[76:79], v[24:27]
    ds_read2_b32 v[106:107], v249 offset0:162 offset1:163
    v_mfma_f32_16x16x32_bf16 v[28:31], v[44:47], v[80:83], v[28:31]
    ds_read2_b32 v[108:109], v249 offset0:32 offset1:33
    v_mfma_f32_16x16x32_bf16 v[16:19], v[48:51], v[64:67], v[16:19]
    ds_read2_b32 v[110:111], v249 offset0:34 offset1:35
    v_mfma_f32_16x16x32_bf16 v[20:23], v[48:51], v[68:71], v[20:23]
    ds_read2_b32 v[112:113], v250 offset0:160 offset1:161
    v_mfma_f32_16x16x32_bf16 v[24:27], v[48:51], v[72:75], v[24:27]
    ds_read2_b32 v[114:115], v250 offset0:162 offset1:163
    v_mfma_f32_16x16x32_bf16 v[28:31], v[48:51], v[76:79], v[28:31]
    ds_read2_b32 v[116:117], v250 offset0:32 offset1:33
    s_waitcnt lgkmcnt(15)
    v_mfma_f32_16x16x32_bf16 v[20:23], v[52:55], v[64:67], v[20:23]
    ds_read2_b32 v[118:119], v250 offset0:34 offset1:35
    v_mfma_f32_16x16x32_bf16 v[24:27], v[52:55], v[68:71], v[24:27]
    ds_read2_b32 v[120:121], v251 offset0:160 offset1:161
    v_mfma_f32_16x16x32_bf16 v[28:31], v[52:55], v[72:75], v[28:31]
    ds_read2_b32 v[122:123], v251 offset0:162 offset1:163
    v_mfma_f32_16x16x32_bf16 v[24:27], v[56:59], v[64:67], v[24:27]
    ds_read2_b32 v[124:125], v251 offset0:32 offset1:33
    ds_read2_b32 v[126:127], v251 offset0:34 offset1:35
    v_mfma_f32_16x16x32_bf16 v[28:31], v[56:59], v[68:71], v[28:31]
    v_mfma_f32_16x16x32_bf16 v[28:31], v[60:63], v[64:67], v[28:31]
    v_mfma_f32_16x16x32_bf16 v[0:3], v[96:99], v[128:131], v[0:3]
    v_mfma_f32_16x16x32_bf16 v[4:7], v[96:99], v[132:135], v[4:7]
    ds_read2_b32 v[32:33], v248 offset0:144 offset1:145
    s_waitcnt lgkmcnt(15)
    v_mfma_f32_16x16x32_bf16 v[8:11], v[96:99], v[136:139], v[8:11]
    ds_read2_b32 v[34:35], v248 offset0:146 offset1:147
    v_mfma_f32_16x16x32_bf16 v[12:15], v[96:99], v[140:143], v[12:15]
    v_mfma_f32_16x16x32_bf16 v[16:19], v[96:99], v[144:147], v[16:19]
    ds_read_b128 v[64:67], v252 offset:64
    v_mfma_f32_16x16x32_bf16 v[20:23], v[96:99], v[148:151], v[20:23]
    ds_read_b128 v[68:71], v252 offset:576
    v_mfma_f32_16x16x32_bf16 v[24:27], v[96:99], v[152:155], v[24:27]
    v_mfma_f32_16x16x32_bf16 v[28:31], v[96:99], v[156:159], v[28:31]
    ds_read_b128 v[72:75], v252 offset:1088
    s_waitcnt lgkmcnt(15)
    v_mfma_f32_16x16x32_bf16 v[4:7], v[100:103], v[128:131], v[4:7]
    ds_read_b128 v[76:79], v252 offset:1600
    v_mfma_f32_16x16x32_bf16 v[8:11], v[100:103], v[132:135], v[8:11]
    ds_read_b128 v[80:83], v252 offset:2112
    v_mfma_f32_16x16x32_bf16 v[12:15], v[100:103], v[136:139], v[12:15]
    v_mfma_f32_16x16x32_bf16 v[16:19], v[100:103], v[140:143], v[16:19]
    ds_read_b128 v[84:87], v252 offset:2624
    v_mfma_f32_16x16x32_bf16 v[20:23], v[100:103], v[144:147], v[20:23]
    ds_read_b128 v[88:91], v252 offset:3136
    v_mfma_f32_16x16x32_bf16 v[24:27], v[100:103], v[148:151], v[24:27]
    v_mfma_f32_16x16x32_bf16 v[28:31], v[100:103], v[152:155], v[28:31]
    ds_read_b128 v[92:95], v252 offset:3648
    v_mfma_f32_16x16x32_bf16 v[8:11], v[104:107], v[128:131], v[8:11]
    ds_read2_b32 v[36:37], v248 offset0:16 offset1:17
    v_mfma_f32_16x16x32_bf16 v[12:15], v[104:107], v[132:135], v[12:15]
    ds_read2_b32 v[38:39], v248 offset0:18 offset1:19
    v_mfma_f32_16x16x32_bf16 v[16:19], v[104:107], v[136:139], v[16:19]
    v_mfma_f32_16x16x32_bf16 v[20:23], v[104:107], v[140:143], v[20:23]
    ds_read2_b32 v[40:41], v249 offset0:144 offset1:145
    v_mfma_f32_16x16x32_bf16 v[24:27], v[104:107], v[144:147], v[24:27]
    ds_read2_b32 v[42:43], v249 offset0:146 offset1:147
    v_mfma_f32_16x16x32_bf16 v[28:31], v[104:107], v[148:151], v[28:31]
    s_waitcnt lgkmcnt(15)
    v_mfma_f32_16x16x32_bf16 v[12:15], v[108:111], v[128:131], v[12:15]
    ds_read2_b32 v[44:45], v249 offset0:16 offset1:17
    s_waitcnt vmcnt(0)
    s_mov_b64 exec, 1
    buffer_store_dword v238, off, s[48:51], s78 sc1
    s_mov_b64 exec, -1
    v_mfma_f32_16x16x32_bf16 v[16:19], v[108:111], v[132:135], v[16:19]
    ds_read2_b32 v[46:47], v249 offset0:18 offset1:19
    v_mfma_f32_16x16x32_bf16 v[20:23], v[108:111], v[136:139], v[20:23]
    v_mfma_f32_16x16x32_bf16 v[24:27], v[108:111], v[140:143], v[24:27]
    ds_read2_b32 v[48:49], v250 offset0:144 offset1:145
    v_mfma_f32_16x16x32_bf16 v[28:31], v[108:111], v[144:147], v[28:31]
    ds_read2_b32 v[50:51], v250 offset0:146 offset1:147
    v_mfma_f32_16x16x32_bf16 v[16:19], v[112:115], v[128:131], v[16:19]
    ds_read2_b32 v[52:53], v250 offset0:16 offset1:17
    buffer_load_dwordx4 a[144:147], v236, s[48:51], s4 offen offset:0 sc1
    v_mfma_f32_16x16x32_bf16 v[20:23], v[112:115], v[132:135], v[20:23]
    v_mfma_f32_16x16x32_bf16 v[24:27], v[112:115], v[136:139], v[24:27]
    ds_read2_b32 v[54:55], v250 offset0:18 offset1:19
    v_mfma_f32_16x16x32_bf16 v[28:31], v[112:115], v[140:143], v[28:31]
    ds_read2_b32 v[56:57], v251 offset0:144 offset1:145
    buffer_load_dwordx4 a[148:151], v237, s[48:51], s4 offen offset:0 sc1
    v_mfma_f32_16x16x32_bf16 v[20:23], v[116:119], v[128:131], v[20:23]
    v_mfma_f32_16x16x32_bf16 v[24:27], v[116:119], v[132:135], v[24:27]
    ds_read2_b32 v[58:59], v251 offset0:146 offset1:147
    v_mfma_f32_16x16x32_bf16 v[28:31], v[116:119], v[136:139], v[28:31]
    ds_read2_b32 v[60:61], v251 offset0:16 offset1:17
    v_mfma_f32_16x16x32_bf16 v[24:27], v[120:123], v[128:131], v[24:27]
    ds_read2_b32 v[62:63], v251 offset0:18 offset1:19
    buffer_load_dwordx4 a[152:155], v236, s[48:51], s4 offen offset:2048 sc1
    v_mfma_f32_16x16x32_bf16 v[28:31], v[120:123], v[132:135], v[28:31]
    s_waitcnt lgkmcnt(15)
    v_mfma_f32_16x16x32_bf16 v[28:31], v[124:127], v[128:131], v[28:31]
    v_mfma_f32_16x16x32_bf16 v[0:3], v[32:35], v[64:67], v[0:3]
    v_mfma_f32_16x16x32_bf16 v[4:7], v[32:35], v[68:71], v[4:7]
    ds_read2_b32 v[96:97], v248 offset0:128 offset1:129
    v_mfma_f32_16x16x32_bf16 v[8:11], v[32:35], v[72:75], v[8:11]
    ds_read2_b32 v[98:99], v248 offset0:130 offset1:131
    v_mfma_f32_16x16x32_bf16 v[12:15], v[32:35], v[76:79], v[12:15]
    buffer_load_dwordx4 a[156:159], v237, s[48:51], s4 offen offset:2048 sc1
    s_add_u32 s4, s4, 4096
    v_mfma_f32_16x16x32_bf16 v[16:19], v[32:35], v[80:83], v[16:19]
    ds_read_b128 v[128:131], v252 offset:0
    v_mfma_f32_16x16x32_bf16 v[20:23], v[32:35], v[84:87], v[20:23]
    ds_read_b128 v[132:135], v252 offset:512
    v_mfma_f32_16x16x32_bf16 v[24:27], v[32:35], v[88:91], v[24:27]
    s_waitcnt lgkmcnt(15)
    v_mfma_f32_16x16x32_bf16 v[28:31], v[32:35], v[92:95], v[28:31]
    ds_read_b128 v[136:139], v252 offset:1024
    buffer_load_dwordx4 a[160:163], v236, s[48:51], s4 offen offset:0 sc1
    v_mfma_f32_16x16x32_bf16 v[4:7], v[36:39], v[64:67], v[4:7]
    ds_read_b128 v[140:143], v252 offset:1536
    v_mfma_f32_16x16x32_bf16 v[8:11], v[36:39], v[68:71], v[8:11]
    ds_read_b128 v[144:147], v252 offset:2048
    v_mfma_f32_16x16x32_bf16 v[12:15], v[36:39], v[72:75], v[12:15]
    v_mfma_f32_16x16x32_bf16 v[16:19], v[36:39], v[76:79], v[16:19]
    ds_read_b128 v[148:151], v252 offset:2560
    buffer_load_dwordx4 a[164:167], v237, s[48:51], s4 offen offset:0 sc1
    v_mfma_f32_16x16x32_bf16 v[20:23], v[36:39], v[80:83], v[20:23]
    ds_read_b128 v[152:155], v252 offset:3072
    v_mfma_f32_16x16x32_bf16 v[24:27], v[36:39], v[84:87], v[24:27]
    v_mfma_f32_16x16x32_bf16 v[28:31], v[36:39], v[88:91], v[28:31]
    ds_read_b128 v[156:159], v252 offset:3584
    s_waitcnt lgkmcnt(15)
    v_mfma_f32_16x16x32_bf16 v[8:11], v[40:43], v[64:67], v[8:11]
    ds_read2_b32 v[100:101], v248 offset0:0 offset1:1
    buffer_load_dwordx4 a[168:171], v236, s[48:51], s4 offen offset:2048 sc1
    v_mfma_f32_16x16x32_bf16 v[12:15], v[40:43], v[68:71], v[12:15]
    ds_read2_b32 v[102:103], v248 offset0:2 offset1:3
    v_mfma_f32_16x16x32_bf16 v[16:19], v[40:43], v[72:75], v[16:19]
    v_mfma_f32_16x16x32_bf16 v[20:23], v[40:43], v[76:79], v[20:23]
    ds_read2_b32 v[104:105], v249 offset0:128 offset1:129
    v_mfma_f32_16x16x32_bf16 v[24:27], v[40:43], v[80:83], v[24:27]
    ds_read2_b32 v[106:107], v249 offset0:130 offset1:131
    buffer_load_dwordx4 a[172:175], v237, s[48:51], s4 offen offset:2048 sc1
    s_add_u32 s4, s4, 4096
    v_mfma_f32_16x16x32_bf16 v[28:31], v[40:43], v[84:87], v[28:31]
    v_mfma_f32_16x16x32_bf16 v[12:15], v[44:47], v[64:67], v[12:15]
    ds_read2_b32 v[108:109], v249 offset0:0 offset1:1
    v_mfma_f32_16x16x32_bf16 v[16:19], v[44:47], v[68:71], v[16:19]
    ds_read2_b32 v[110:111], v249 offset0:2 offset1:3
    v_mfma_f32_16x16x32_bf16 v[20:23], v[44:47], v[72:75], v[20:23]
    buffer_load_dwordx4 a[176:179], v236, s[48:51], s4 offen offset:0 sc1
    v_mfma_f32_16x16x32_bf16 v[24:27], v[44:47], v[76:79], v[24:27]
    ds_read2_b32 v[112:113], v250 offset0:128 offset1:129
    v_mfma_f32_16x16x32_bf16 v[28:31], v[44:47], v[80:83], v[28:31]
    ds_read2_b32 v[114:115], v250 offset0:130 offset1:131
    v_mfma_f32_16x16x32_bf16 v[16:19], v[48:51], v[64:67], v[16:19]
    ds_read2_b32 v[116:117], v250 offset0:0 offset1:1
    v_mfma_f32_16x16x32_bf16 v[20:23], v[48:51], v[68:71], v[20:23]
    buffer_load_dwordx4 a[180:183], v237, s[48:51], s4 offen offset:0 sc1
    v_mfma_f32_16x16x32_bf16 v[24:27], v[48:51], v[72:75], v[24:27]
    ds_read2_b32 v[118:119], v250 offset0:2 offset1:3
    v_mfma_f32_16x16x32_bf16 v[28:31], v[48:51], v[76:79], v[28:31]
    ds_read2_b32 v[120:121], v251 offset0:128 offset1:129
    s_waitcnt lgkmcnt(15)
    v_mfma_f32_16x16x32_bf16 v[20:23], v[52:55], v[64:67], v[20:23]
    v_mfma_f32_16x16x32_bf16 v[24:27], v[52:55], v[68:71], v[24:27]
    ds_read2_b32 v[122:123], v251 offset0:130 offset1:131
    buffer_load_dwordx4 a[184:187], v236, s[48:51], s4 offen offset:2048 sc1
    v_mfma_f32_16x16x32_bf16 v[28:31], v[52:55], v[72:75], v[28:31]
    ds_read2_b32 v[124:125], v251 offset0:0 offset1:1
    v_mfma_f32_16x16x32_bf16 v[24:27], v[56:59], v[64:67], v[24:27]
    ds_read2_b32 v[126:127], v251 offset0:2 offset1:3
    v_mfma_f32_16x16x32_bf16 v[28:31], v[56:59], v[68:71], v[28:31]
    v_mfma_f32_16x16x32_bf16 v[28:31], v[60:63], v[64:67], v[28:31]
    v_mfma_f32_16x16x32_bf16 v[0:3], v[96:99], v[128:131], v[0:3]
    buffer_load_dwordx4 a[188:191], v237, s[48:51], s4 offen offset:2048 sc1
    s_add_u32 s4, s4, 4096
    v_mfma_f32_16x16x32_bf16 v[4:7], v[96:99], v[132:135], v[4:7]
    v_mfma_f32_16x16x32_bf16 v[8:11], v[96:99], v[136:139], v[8:11]
    v_mfma_f32_16x16x32_bf16 v[12:15], v[96:99], v[140:143], v[12:15]
    s_nop 2
    ds_write_b128 v246, v[0:3] offset:0
    s_waitcnt lgkmcnt(15)
    v_mfma_f32_16x16x32_bf16 v[16:19], v[96:99], v[144:147], v[16:19]
    buffer_load_dwordx4 a[192:195], v236, s[48:51], s4 offen offset:0 sc1
    s_mul_i32 s80, s66, 1835008
    s_lshl_b32 s81, s69, 10
    s_add_u32 s80, s80, s81
    s_add_u32 s80, s80, 6291456
    s_add_u32 s7, s80, 1835008
    s_lshl_b32 s81, s8, 17
    s_add_u32 s6, s80, s81
    s_lshr_b32 s81, s66, 1
    s_lshl_b32 s81, s81, 9
    v_lshrrev_b32 v182, 5, v255
    v_mfma_f32_16x16x32_bf16 v[20:23], v[96:99], v[148:151], v[20:23]
    v_mfma_f32_16x16x32_bf16 v[24:27], v[96:99], v[152:155], v[24:27]
    v_and_b32 v183, 31, v255
    v_mfma_f32_16x16x32_bf16 v[28:31], v[96:99], v[156:159], v[28:31]
    s_waitcnt lgkmcnt(13)
    v_mfma_f32_16x16x32_bf16 v[4:7], v[100:103], v[128:131], v[4:7]
    buffer_load_dwordx4 a[196:199], v237, s[48:51], s4 offen offset:0 sc1
    v_lshl_add_u32 v183, v183, 4, s81
    v_mfma_f32_16x16x32_bf16 v[8:11], v[100:103], v[132:135], v[8:11]
    v_mfma_f32_16x16x32_bf16 v[12:15], v[100:103], v[136:139], v[12:15]
    v_lshl_add_u32 v160, v182, 15, v183
    v_mfma_f32_16x16x32_bf16 v[16:19], v[100:103], v[140:143], v[16:19]
    s_nop 1
    ds_write_b128 v246, v[4:7] offset:1024
    v_mfma_f32_16x16x32_bf16 v[20:23], v[100:103], v[144:147], v[20:23]
    buffer_load_dwordx4 a[200:203], v236, s[48:51], s4 offen offset:2048 sc1
    v_xor_b32 v161, 512, v160
    v_mfma_f32_16x16x32_bf16 v[24:27], v[100:103], v[148:151], v[24:27]
    v_mfma_f32_16x16x32_bf16 v[28:31], v[100:103], v[152:155], v[28:31]
    s_waitcnt lgkmcnt(12)
    v_mfma_f32_16x16x32_bf16 v[8:11], v[104:107], v[128:131], v[8:11]
    v_mfma_f32_16x16x32_bf16 v[12:15], v[104:107], v[132:135], v[12:15]
    buffer_load_dwordx4 a[204:207], v237, s[48:51], s4 offen offset:2048 sc1
    s_add_u32 s4, s4, 4096
    v_mfma_f32_16x16x32_bf16 v[16:19], v[104:107], v[136:139], v[16:19]
    v_mfma_f32_16x16x32_bf16 v[20:23], v[104:107], v[140:143], v[20:23]
    s_nop 2
    ds_write_b128 v246, v[8:11] offset:2048
    buffer_load_dword v244, v242, s[48:51], 0 offen sc1
    v_mfma_f32_16x16x32_bf16 v[24:27], v[104:107], v[144:147], v[24:27]
    v_mfma_f32_16x16x32_bf16 v[28:31], v[104:107], v[148:151], v[28:31]
    buffer_load_dwordx4 a[208:211], v236, s[48:51], s4 offen offset:0 sc1
    s_waitcnt lgkmcnt(11)
    v_mfma_f32_16x16x32_bf16 v[12:15], v[108:111], v[128:131], v[12:15]
    v_mfma_f32_16x16x32_bf16 v[16:19], v[108:111], v[132:135], v[16:19]
    v_mfma_f32_16x16x32_bf16 v[20:23], v[108:111], v[136:139], v[20:23]
    v_mfma_f32_16x16x32_bf16 v[24:27], v[108:111], v[140:143], v[24:27]
    s_nop 4
    ds_write_b128 v246, v[12:15] offset:3072
    buffer_load_dwordx4 a[212:215], v237, s[48:51], s4 offen offset:0 sc1
    v_mfma_f32_16x16x32_bf16 v[28:31], v[108:111], v[144:147], v[28:31]
    s_waitcnt lgkmcnt(10)
    v_mfma_f32_16x16x32_bf16 v[16:19], v[112:115], v[128:131], v[16:19]
    v_mfma_f32_16x16x32_bf16 v[20:23], v[112:115], v[132:135], v[20:23]
    v_mfma_f32_16x16x32_bf16 v[24:27], v[112:115], v[136:139], v[24:27]
    buffer_load_dwordx4 a[216:219], v236, s[48:51], s4 offen offset:2048 sc1
    v_mfma_f32_16x16x32_bf16 v[28:31], v[112:115], v[140:143], v[28:31]
    s_nop 3
    ds_write_b128 v246, v[16:19] offset:4096
    s_waitcnt lgkmcnt(9)
    v_mfma_f32_16x16x32_bf16 v[20:23], v[116:119], v[128:131], v[20:23]
    v_mfma_f32_16x16x32_bf16 v[24:27], v[116:119], v[132:135], v[24:27]
    v_mfma_f32_16x16x32_bf16 v[28:31], v[116:119], v[136:139], v[28:31]
    buffer_load_dwordx4 a[220:223], v237, s[48:51], s4 offen offset:2048 sc1
    s_waitcnt lgkmcnt(7)
    v_mfma_f32_16x16x32_bf16 v[24:27], v[120:123], v[128:131], v[24:27]
    s_nop 2
    ds_write_b128 v246, v[20:23] offset:5120
    v_mfma_f32_16x16x32_bf16 v[28:31], v[120:123], v[132:135], v[28:31]
    s_waitcnt lgkmcnt(6)
    v_mfma_f32_16x16x32_bf16 v[28:31], v[124:127], v[128:131], v[28:31]
    s_nop 0
    ds_write_b128 v246, v[24:27] offset:6144
    s_nop 5
    ds_write_b128 v246, v[28:31] offset:7168
    s_waitcnt lgkmcnt(0)
    s_barrier
    ds_read_b128 v[32:35], v247 offset:0
    ds_read_b128 v[40:43], v247 offset:8192
    ds_read_b128 v[36:39], v247 offset:256
    ds_read_b128 v[44:47], v247 offset:8448
    ds_read_b128 v[48:51], v247 offset:2048
    ds_read_b128 v[56:59], v247 offset:10240
    ds_read_b128 v[52:55], v247 offset:2304
    ds_read_b128 v[60:63], v247 offset:10496
    s_waitcnt vmcnt(4)
    v_cmp_ne_u32 vcc, 1, v244
    s_nop 4
    s_cbranch_vccnz L_slow_13
L_ret_14:
    buffer_load_dwordx4 v[64:67], v160, s[48:51], s6 offen sc1
    buffer_load_dwordx4 v[68:71], v161, s[48:51], s6 offen sc1
    s_add_u32 s6, s6, 65536
    buffer_load_dwordx4 v[72:75], v160, s[48:51], s6 offen sc1
    buffer_load_dwordx4 v[76:79], v161, s[48:51], s6 offen sc1
    s_add_u32 s6, s6, 65536
    buffer_load_dwordx4 v[80:83], v160, s[48:51], s6 offen sc1
    buffer_load_dwordx4 v[84:87], v161, s[48:51], s6 offen sc1
    s_add_u32 s6, s6, 65536
    buffer_load_dwordx4 v[88:91], v160, s[48:51], s6 offen sc1
    buffer_load_dwordx4 v[92:95], v161, s[48:51], s6 offen sc1
    s_add_u32 s6, s6, 65536
    s_waitcnt lgkmcnt(6)
    v_pk_add_f32 v[32:33], v[32:33], v[40:41]
    v_pk_add_f32 v[34:35], v[34:35], v[42:43]
    s_waitcnt lgkmcnt(4)
    v_pk_add_f32 v[36:37], v[36:37], v[44:45]
    v_pk_add_f32 v[38:39], v[38:39], v[46:47]
    v_cvt_pk_bf16_f32 v0, v32, v33
    v_cvt_pk_bf16_f32 v1, v34, v35
    v_cvt_pk_bf16_f32 v2, v36, v37
    v_cvt_pk_bf16_f32 v3, v38, v39
    buffer_store_dwordx4 v[0:3], v234, s[48:51], s13 offen offset:0 sc1
    s_waitcnt lgkmcnt(2)
    v_pk_add_f32 v[48:49], v[48:49], v[56:57]
    v_pk_add_f32 v[50:51], v[50:51], v[58:59]
    s_waitcnt lgkmcnt(0)
    v_pk_add_f32 v[52:53], v[52:53], v[60:61]
    v_pk_add_f32 v[54:55], v[54:55], v[62:63]
    v_cvt_pk_bf16_f32 v4, v48, v49
    v_cvt_pk_bf16_f32 v5, v50, v51
    v_cvt_pk_bf16_f32 v6, v52, v53
    v_cvt_pk_bf16_f32 v7, v54, v55
    buffer_store_dwordx4 v[4:7], v234, s[48:51], s13 offen offset:1024 sc1
    s_lshr_b32 s81, s66, 1
    s_lshl_b32 s82, s69, 1
    s_add_u32 s81, s81, s82
    s_lshl_b32 s81, s81, 7
    s_add_u32 s81, s81, 5242880
    v_and_b32 v235, 31, v255
    v_lshlrev_b32 v235, 2, v235
    buffer_load_dword v246, v235, s[48:51], s81 offen sc1
    buffer_load_dwordx4 v[96:99], v160, s[48:51], s6 offen sc1
    buffer_load_dwordx4 v[100:103], v161, s[48:51], s6 offen sc1
    s_add_u32 s6, s6, 65536
    buffer_load_dwordx4 v[104:107], v160, s[48:51], s6 offen sc1
    buffer_load_dwordx4 v[108:111], v161, s[48:51], s6 offen sc1
    s_add_u32 s6, s6, 65536
    s_xor_b32 s80, s66, 1
    s_mul_i32 s80, s80, 12288
    s_add_u32 s80, s80, 49152
    v_lshl_add_u32 v192, v255, 4, s80
    s_xor_b32 s80, s66, 2
    s_mul_i32 s80, s80, 12288
    s_add_u32 s80, s80, 53248
    v_lshl_add_u32 v193, v255, 4, s80
    s_xor_b32 s80, s66, 3
    s_mul_i32 s80, s80, 12288
    s_add_u32 s80, s80, 57344
    v_lshl_add_u32 v194, v255, 4, s80
    s_mul_i32 s80, s66, 12288
    s_add_u32 s80, s80, 49152
    v_lshl_add_u32 v195, v255, 4, s80
    s_lshr_b32 s81, s66, 1
    s_lshl_b32 s82, s69, 1
    s_add_u32 s81, s81, s82
    s_lshl_b32 s81, s81, 15
    s_and_b32 s80, s66, 1
    s_lshl_b32 s82, s70, 1
    s_add_u32 s80, s80, s82
    s_lshl_b32 s80, s80, 6
    s_add_u32 s80, s80, s81
    v_and_b32 v182, 31, v255
    v_lshrrev_b32 v183, 5, v255
    v_lshl_add_u32 v183, v183, 4, s80
    v_lshl_add_u32 v196, v182, 10, v183
    s_waitcnt vmcnt(14)
    v_mfma_f32_32x32x16_bf16 v[0:15], a[0:3], v[64:67], 0
    v_mfma_f32_32x32x16_bf16 v[16:31], a[4:7], v[64:67], 0
    buffer_load_dwordx4 v[112:115], v160, s[48:51], s6 offen sc1
    s_waitcnt vmcnt(14)
    v_mfma_f32_32x32x16_bf16 v[32:47], a[0:3], v[68:71], 0
    v_mfma_f32_32x32x16_bf16 v[48:63], a[4:7], v[68:71], 0
    buffer_load_dwordx4 v[116:119], v161, s[48:51], s6 offen sc1
    s_add_u32 s6, s6, 65536
    s_waitcnt vmcnt(14)
    v_mfma_f32_32x32x16_bf16 v[0:15], a[8:11], v[72:75], v[0:15]
    v_mfma_f32_32x32x16_bf16 v[16:31], a[12:15], v[72:75], v[16:31]
    buffer_load_dwordx4 v[120:123], v160, s[48:51], s6 offen sc1
    s_waitcnt vmcnt(14)
    v_mfma_f32_32x32x16_bf16 v[32:47], a[8:11], v[76:79], v[32:47]
    v_mfma_f32_32x32x16_bf16 v[48:63], a[12:15], v[76:79], v[48:63]
    buffer_load_dwordx4 v[124:127], v161, s[48:51], s6 offen sc1
    s_add_u32 s6, s6, 65536
    s_waitcnt vmcnt(14)
    v_mfma_f32_32x32x16_bf16 v[0:15], a[16:19], v[80:83], v[0:15]
    v_mfma_f32_32x32x16_bf16 v[16:31], a[20:23], v[80:83], v[16:31]
    buffer_load_dwordx4 v[128:131], v160, s[48:51], s6 offen sc1
    s_waitcnt vmcnt(14)
    v_mfma_f32_32x32x16_bf16 v[32:47], a[16:19], v[84:87], v[32:47]
    v_mfma_f32_32x32x16_bf16 v[48:63], a[20:23], v[84:87], v[48:63]
    buffer_load_dwordx4 v[132:135], v161, s[48:51], s6 offen sc1
    s_add_u32 s6, s6, 65536
    s_waitcnt vmcnt(14)
    v_mfma_f32_32x32x16_bf16 v[0:15], a[24:27], v[88:91], v[0:15]
    v_mfma_f32_32x32x16_bf16 v[16:31], a[28:31], v[88:91], v[16:31]
    s_waitcnt vmcnt(11)
    buffer_load_dwordx4 v[136:139], v160, s[48:51], s6 offen sc1
    v_mfma_f32_32x32x16_bf16 v[32:47], a[24:27], v[92:95], v[32:47]
    v_mfma_f32_32x32x16_bf16 v[48:63], a[28:31], v[92:95], v[48:63]
    s_mov_b64 exec, 1
    buffer_store_dword v238, off, s[48:51], s79 sc1
    s_mov_b64 exec, -1
    buffer_load_dwordx4 v[140:143], v161, s[48:51], s6 offen sc1
    s_add_u32 s6, s6, 65536
    s_waitcnt vmcnt(12)
    v_mfma_f32_32x32x16_bf16 v[0:15], a[32:35], v[96:99], v[0:15]
    v_mfma_f32_32x32x16_bf16 v[16:31], a[36:39], v[96:99], v[16:31]
    buffer_load_dwordx4 v[144:147], v160, s[48:51], s6 offen sc1
    s_waitcnt vmcnt(12)
    v_mfma_f32_32x32x16_bf16 v[32:47], a[32:35], v[100:103], v[32:47]
    v_mfma_f32_32x32x16_bf16 v[48:63], a[36:39], v[100:103], v[48:63]
    buffer_load_dwordx4 v[148:151], v161, s[48:51], s6 offen sc1
    s_add_u32 s6, s6, 65536
    s_waitcnt vmcnt(12)
    v_mfma_f32_32x32x16_bf16 v[0:15], a[40:43], v[104:107], v[0:15]
    v_mfma_f32_32x32x16_bf16 v[16:31], a[44:47], v[104:107], v[16:31]
    buffer_load_dwordx4 v[152:155], v160, s[48:51], s6 offen sc1
    s_waitcnt vmcnt(12)
    v_mfma_f32_32x32x16_bf16 v[32:47], a[40:43], v[108:111], v[32:47]
    v_mfma_f32_32x32x16_bf16 v[48:63], a[44:47], v[108:111], v[48:63]
    buffer_load_dwordx4 v[156:159], v161, s[48:51], s6 offen sc1
    s_add_u32 s6, s6, 65536
    s_waitcnt vmcnt(12)
    v_mfma_f32_32x32x16_bf16 v[0:15], a[48:51], v[112:115], v[0:15]
    v_mfma_f32_32x32x16_bf16 v[16:31], a[52:55], v[112:115], v[16:31]
    buffer_load_dwordx4 v[64:67], v160, s[48:51], s6 offen sc1
    s_waitcnt vmcnt(12)
    v_mfma_f32_32x32x16_bf16 v[32:47], a[48:51], v[116:119], v[32:47]
    v_mfma_f32_32x32x16_bf16 v[48:63], a[52:55], v[116:119], v[48:63]
    buffer_load_dwordx4 v[68:71], v161, s[48:51], s6 offen sc1
    s_add_u32 s6, s6, 65536
    s_waitcnt vmcnt(12)
    v_mfma_f32_32x32x16_bf16 v[0:15], a[56:59], v[120:123], v[0:15]
    v_mfma_f32_32x32x16_bf16 v[16:31], a[60:63], v[120:123], v[16:31]
    buffer_load_dwordx4 v[72:75], v160, s[48:51], s6 offen sc1
    s_waitcnt vmcnt(12)
    v_mfma_f32_32x32x16_bf16 v[32:47], a[56:59], v[124:127], v[32:47]
    v_mfma_f32_32x32x16_bf16 v[48:63], a[60:63], v[124:127], v[48:63]
    buffer_load_dwordx4 v[76:79], v161, s[48:51], s6 offen sc1
    s_add_u32 s6, s6, 65536
    s_waitcnt vmcnt(12)
    v_mfma_f32_32x32x16_bf16 v[0:15], a[64:67], v[128:131], v[0:15]
    v_mfma_f32_32x32x16_bf16 v[16:31], a[68:71], v[128:131], v[16:31]
    buffer_load_dwordx4 v[80:83], v160, s[48:51], s6 offen sc1
    s_waitcnt vmcnt(12)
    v_mfma_f32_32x32x16_bf16 v[32:47], a[64:67], v[132:135], v[32:47]
    v_mfma_f32_32x32x16_bf16 v[48:63], a[68:71], v[132:135], v[48:63]
    buffer_load_dwordx4 v[84:87], v161, s[48:51], s6 offen sc1
    s_add_u32 s6, s6, 65536
    s_waitcnt vmcnt(12)
    v_mfma_f32_32x32x16_bf16 v[0:15], a[72:75], v[136:139], v[0:15]
    v_mfma_f32_32x32x16_bf16 v[16:31], a[76:79], v[136:139], v[16:31]
    buffer_load_dwordx4 v[88:91], v160, s[48:51], s6 offen sc1
    s_waitcnt vmcnt(11)
    v_mfma_f32_32x32x16_bf16 v[32:47], a[72:75], v[140:143], v[32:47]
    v_mfma_f32_32x32x16_bf16 v[48:63], a[76:79], v[140:143], v[48:63]
    buffer_load_dwordx4 v[92:95], v161, s[48:51], s6 offen sc1
    s_add_u32 s6, s6, 65536
    s_waitcnt vmcnt(11)
    v_mfma_f32_32x32x16_bf16 v[0:15], a[80:83], v[144:147], v[0:15]
    v_mfma_f32_32x32x16_bf16 v[16:31], a[84:87], v[144:147], v[16:31]
    buffer_load_dwordx4 v[96:99], v160, s[48:51], s6 offen sc1
    s_waitcnt vmcnt(11)
    v_mfma_f32_32x32x16_bf16 v[32:47], a[80:83], v[148:151], v[32:47]
    v_mfma_f32_32x32x16_bf16 v[48:63], a[84:87], v[148:151], v[48:63]
    buffer_load_dwordx4 v[100:103], v161, s[48:51], s6 offen sc1
    s_add_u32 s6, s6, 65536
    s_waitcnt vmcnt(11)
    v_mfma_f32_32x32x16_bf16 v[0:15], a[88:91], v[152:155], v[0:15]
    v_mfma_f32_32x32x16_bf16 v[16:31], a[92:95], v[152:155], v[16:31]
    buffer_load_dwordx4 v[104:107], v160, s[48:51], s6 offen sc1
    s_waitcnt vmcnt(11)
    v_mfma_f32_32x32x16_bf16 v[32:47], a[88:91], v[156:159], v[32:47]
    v_mfma_f32_32x32x16_bf16 v[48:63], a[92:95], v[156:159], v[48:63]
    buffer_load_dwordx4 v[108:111], v161, s[48:51], s6 offen sc1
    s_add_u32 s6, s6, 65536
    s_waitcnt vmcnt(11)
    v_mfma_f32_32x32x16_bf16 v[0:15], a[96:99], v[64:67], v[0:15]
    v_mfma_f32_32x32x16_bf16 v[16:31], a[100:103], v[64:67], v[16:31]
    buffer_load_dwordx4 v[112:115], v160, s[48:51], s6 offen sc1
    s_waitcnt vmcnt(11)
    v_mfma_f32_32x32x16_bf16 v[32:47], a[96:99], v[68:71], v[32:47]
    v_mfma_f32_32x32x16_bf16 v[48:63], a[100:103], v[68:71], v[48:63]
    buffer_load_dwordx4 v[116:119], v161, s[48:51], s6 offen sc1
    s_add_u32 s6, s6, 65536
    s_waitcnt vmcnt(11)
    v_mfma_f32_32x32x16_bf16 v[0:15], a[104:107], v[72:75], v[0:15]
    v_mfma_f32_32x32x16_bf16 v[16:31], a[108:111], v[72:75], v[16:31]
    buffer_load_dwordx4 v[120:123], v160, s[48:51], s6 offen sc1
    s_waitcnt vmcnt(11)
    v_mfma_f32_32x32x16_bf16 v[32:47], a[104:107], v[76:79], v[32:47]
    v_mfma_f32_32x32x16_bf16 v[48:63], a[108:111], v[76:79], v[48:63]
    buffer_load_dwordx4 v[124:127], v161, s[48:51], s6 offen sc1
    s_add_u32 s6, s6, 65536
    s_waitcnt vmcnt(11)
    v_mfma_f32_32x32x16_bf16 v[0:15], a[112:115], v[80:83], v[0:15]
    v_mfma_f32_32x32x16_bf16 v[16:31], a[116:119], v[80:83], v[16:31]
    buffer_load_dwordx4 v[128:131], v160, s[48:51], s6 offen sc1
    s_waitcnt vmcnt(11)
    v_mfma_f32_32x32x16_bf16 v[32:47], a[112:115], v[84:87], v[32:47]
    v_mfma_f32_32x32x16_bf16 v[48:63], a[116:119], v[84:87], v[48:63]
    buffer_load_dwordx4 v[132:135], v161, s[48:51], s6 offen sc1
    s_add_u32 s6, s6, 65536
    s_waitcnt vmcnt(11)
    v_mfma_f32_32x32x16_bf16 v[0:15], a[120:123], v[88:91], v[0:15]
    v_mfma_f32_32x32x16_bf16 v[16:31], a[124:127], v[88:91], v[16:31]
    buffer_load_dwordx4 v[136:139], v160, s[48:51], s6 offen sc1
    s_waitcnt vmcnt(11)
    v_mfma_f32_32x32x16_bf16 v[32:47], a[120:123], v[92:95], v[32:47]
    v_mfma_f32_32x32x16_bf16 v[48:63], a[124:127], v[92:95], v[48:63]
    buffer_load_dwordx4 v[140:143], v161, s[48:51], s6 offen sc1
    s_add_u32 s6, s6, 65536
    s_waitcnt vmcnt(11)
    v_mfma_f32_32x32x16_bf16 v[0:15], a[128:131], v[96:99], v[0:15]
    v_mfma_f32_32x32x16_bf16 v[16:31], a[132:135], v[96:99], v[16:31]
    buffer_load_dwordx4 v[144:147], v160, s[48:51], s6 offen sc1
    s_waitcnt vmcnt(11)
    v_mfma_f32_32x32x16_bf16 v[32:47], a[128:131], v[100:103], v[32:47]
    v_mfma_f32_32x32x16_bf16 v[48:63], a[132:135], v[100:103], v[48:63]
    buffer_load_dwordx4 v[148:151], v161, s[48:51], s6 offen sc1
    s_add_u32 s6, s6, 65536
    s_waitcnt vmcnt(11)
    v_mfma_f32_32x32x16_bf16 v[0:15], a[136:139], v[104:107], v[0:15]
    v_mfma_f32_32x32x16_bf16 v[16:31], a[140:143], v[104:107], v[16:31]
    buffer_load_dwordx4 v[152:155], v160, s[48:51], s6 offen sc1
    s_waitcnt vmcnt(11)
    v_mfma_f32_32x32x16_bf16 v[32:47], a[136:139], v[108:111], v[32:47]
    v_mfma_f32_32x32x16_bf16 v[48:63], a[140:143], v[108:111], v[48:63]
    buffer_load_dword v244, v243, s[48:51], 0 offen sc1
    buffer_load_dwordx4 v[156:159], v161, s[48:51], s6 offen sc1
    s_add_u32 s6, s6, 65536
    s_waitcnt vmcnt(12)
    v_mfma_f32_32x32x16_bf16 v[0:15], a[144:147], v[112:115], v[0:15]
    v_mfma_f32_32x32x16_bf16 v[16:31], a[148:151], v[112:115], v[16:31]
    buffer_load_dwordx4 v[64:67], v160, s[48:51], s6 offen sc1
    s_waitcnt vmcnt(12)
    v_mfma_f32_32x32x16_bf16 v[32:47], a[144:147], v[116:119], v[32:47]
    v_mfma_f32_32x32x16_bf16 v[48:63], a[148:151], v[116:119], v[48:63]
    buffer_load_dwordx4 v[68:71], v161, s[48:51], s6 offen sc1
    s_add_u32 s6, s6, 65536
    s_waitcnt vmcnt(12)
    v_mfma_f32_32x32x16_bf16 v[0:15], a[152:155], v[120:123], v[0:15]
    v_mfma_f32_32x32x16_bf16 v[16:31], a[156:159], v[120:123], v[16:31]
    buffer_load_dwordx4 v[72:75], v160, s[48:51], s6 offen sc1
    s_waitcnt vmcnt(12)
    v_mfma_f32_32x32x16_bf16 v[32:47], a[152:155], v[124:127], v[32:47]
    v_mfma_f32_32x32x16_bf16 v[48:63], a[156:159], v[124:127], v[48:63]
    buffer_load_dwordx4 v[76:79], v161, s[48:51], s6 offen sc1
    s_add_u32 s6, s6, 65536
    s_waitcnt vmcnt(12)
    v_mfma_f32_32x32x16_bf16 v[0:15], a[160:163], v[128:131], v[0:15]
    v_mfma_f32_32x32x16_bf16 v[16:31], a[164:167], v[128:131], v[16:31]
    buffer_load_dwordx4 v[80:83], v160, s[48:51], s6 offen sc1
    s_waitcnt vmcnt(12)
    v_mfma_f32_32x32x16_bf16 v[32:47], a[160:163], v[132:135], v[32:47]
    v_mfma_f32_32x32x16_bf16 v[48:63], a[164:167], v[132:135], v[48:63]
    buffer_load_dwordx4 v[84:87], v161, s[48:51], s6 offen sc1
    s_add_u32 s6, s6, 65536
    s_waitcnt vmcnt(12)
    v_mfma_f32_32x32x16_bf16 v[0:15], a[168:171], v[136:139], v[0:15]
    s_waitcnt vmcnt(7)
    v_cmp_ne_u32 vcc, 1, v244
    s_nop 4
    s_cbranch_vccnz L_slow_16
L_ret_17:
    v_mfma_f32_32x32x16_bf16 v[16:31], a[172:175], v[136:139], v[16:31]
    s_and_b32 s80, s66, 1
    s_lshl_b32 s81, s70, 1
    s_add_u32 s80, s80, s81
    s_lshl_b32 s80, s80, 17
    s_lshr_b32 s81, s66, 1
    s_lshl_b32 s82, s69, 1
    s_add_u32 s81, s81, s82
    s_lshl_b32 s82, s81, 6
    s_add_u32 s80, s80, s82
    s_add_u32 s11, s80, 13631488
    s_add_u32 s12, s11, 65536
    buffer_load_dwordx4 v[88:91], v160, s[48:51], s6 offen sc1
    v_mfma_f32_32x32x16_bf16 v[32:47], a[168:171], v[140:143], v[32:47]
    v_lshrrev_b32 v182, 2, v255
    v_and_b32 v183, 3, v255
    v_lshlrev_b32 v183, 4, v183
    v_lshl_add_u32 v182, v182, 12, v183
    v_mfma_f32_32x32x16_bf16 v[48:63], a[172:175], v[140:143], v[48:63]
    buffer_load_dwordx4 v[184:187], v182, s[48:51], s11 offen sc1
    buffer_load_dwordx4 v[188:191], v182, s[48:51], s12 offen sc1
    buffer_load_dwordx4 v[92:95], v161, s[48:51], s6 offen sc1
    v_mfma_f32_32x32x16_bf16 v[0:15], a[176:179], v[144:147], v[0:15]
    v_mfma_f32_32x32x16_bf16 v[16:31], a[180:183], v[144:147], v[16:31]
    v_mfma_f32_32x32x16_bf16 v[32:47], a[176:179], v[148:151], v[32:47]
    v_mfma_f32_32x32x16_bf16 v[48:63], a[180:183], v[148:151], v[48:63]
    v_mfma_f32_32x32x16_bf16 v[0:15], a[184:187], v[152:155], v[0:15]
    v_mfma_f32_32x32x16_bf16 v[16:31], a[188:191], v[152:155], v[16:31]
    s_waitcnt vmcnt(10)
    v_mfma_f32_32x32x16_bf16 v[32:47], a[184:187], v[156:159], v[32:47]
    v_mfma_f32_32x32x16_bf16 v[48:63], a[188:191], v[156:159], v[48:63]
    s_waitcnt vmcnt(8)
    v_mfma_f32_32x32x16_bf16 v[48:63], a[196:199], v[68:71], v[48:63]
    s_lshl_b32 s80, s66, 11
    s_add_u32 s80, s80, 32768
    v_lshl_add_u32 v182, v255, 4, s80
    v_lshrrev_b32 v183, 5, v255
    v_bfe_u32 v162, v255, 2, 2
    v_lshl_add_u32 v183, v183, 2, v162
    s_waitcnt vmcnt(6)
    v_mfma_f32_32x32x16_bf16 v[48:63], a[204:207], v[76:79], v[48:63]
    v_bfe_u32 v162, v255, 4, 1
    v_lshl_add_u32 v183, v183, 1, v162
    v_and_b32 v162, 3, v255
    v_lshl_add_u32 v183, v183, 2, v162
    v_lshl_add_u32 v183, v183, 3, s80
    s_waitcnt vmcnt(4)
    v_mfma_f32_32x32x16_bf16 v[48:63], a[212:215], v[84:87], v[48:63]
    s_waitcnt vmcnt(2)
    ds_write_b128 v182, v[184:187]
    s_waitcnt vmcnt(1)
    ds_write_b128 v182, v[188:191] offset:1024
    s_waitcnt vmcnt(0)
    v_mfma_f32_32x32x16_bf16 v[48:63], a[220:223], v[92:95], v[48:63]
    ds_read_b64_tr_b16 v[184:185], v183 offset:0
    ds_read_b64_tr_b16 v[186:187], v183 offset:512
    v_mfma_f32_32x32x16_bf16 v[16:31], a[196:199], v[64:67], v[16:31]
    ds_read_b64_tr_b16 v[188:189], v183 offset:1024
    ds_read_b64_tr_b16 v[190:191], v183 offset:1536
    v_mfma_f32_32x32x16_bf16 v[16:31], a[204:207], v[72:75], v[16:31]
    s_nop 5
    ds_write_b128 v194, v[48:51] offset:0
    ds_write_b128 v194, v[52:55] offset:1024
    v_sub_f32 v247, 1.0, v246
    v_cvt_pk_bf16_f32 v247, v247, v247
    v_and_b32 v247, 0xffff0000, v247
    s_waitcnt lgkmcnt(5)
    v_lshlrev_b32 v164, 16, v184
    v_and_b32 v165, 0xffff0000, v184
    v_mfma_f32_32x32x16_bf16 v[16:31], a[212:215], v[80:83], v[16:31]
    ds_write_b128 v194, v[56:59] offset:2048
    ds_write_b128 v194, v[60:63] offset:3072
    v_mul_f32 v164, v246, v164
    v_mul_f32 v165, v246, v165
    v_lshlrev_b32 v166, 16, v185
    v_and_b32 v167, 0xffff0000, v185
    v_mfma_f32_32x32x16_bf16 v[16:31], a[220:223], v[88:91], v[16:31]
    v_mul_f32 v166, v246, v166
    v_mul_f32 v167, v246, v167
    s_waitcnt lgkmcnt(6)
    v_lshlrev_b32 v168, 16, v186
    v_and_b32 v169, 0xffff0000, v186
    v_mfma_f32_32x32x16_bf16 v[32:47], a[192:195], v[68:71], v[32:47]
    v_mul_f32 v168, v246, v168
    v_mul_f32 v169, v246, v169
    v_lshlrev_b32 v170, 16, v187
    v_and_b32 v171, 0xffff0000, v187
    v_mfma_f32_32x32x16_bf16 v[32:47], a[200:203], v[76:79], v[32:47]
    s_nop 0
    ds_write_b128 v192, v[16:19] offset:0
    ds_write_b128 v192, v[20:23] offset:1024
    v_mul_f32 v170, v246, v170
    v_mul_f32 v171, v246, v171
    s_waitcnt lgkmcnt(7)
    v_lshlrev_b32 v172, 16, v188
    v_and_b32 v173, 0xffff0000, v188
    v_mfma_f32_32x32x16_bf16 v[32:47], a[208:211], v[84:87], v[32:47]
    ds_write_b128 v192, v[24:27] offset:2048
    ds_write_b128 v192, v[28:31] offset:3072
    v_mul_f32 v172, v246, v172
    v_mul_f32 v173, v246, v173
    v_lshlrev_b32 v174, 16, v189
    v_and_b32 v175, 0xffff0000, v189
    v_mfma_f32_32x32x16_bf16 v[32:47], a[216:219], v[92:95], v[32:47]
    v_mul_f32 v174, v246, v174
    v_mul_f32 v175, v246, v175
    s_waitcnt lgkmcnt(8)
    v_lshlrev_b32 v176, 16, v190
    v_and_b32 v177, 0xffff0000, v190
    v_mfma_f32_32x32x16_bf16 v[0:15], a[192:195], v[64:67], v[0:15]
    v_mul_f32 v176, v246, v176
    v_mul_f32 v177, v246, v177
    v_lshlrev_b32 v178, 16, v191
    v_and_b32 v179, 0xffff0000, v191
    v_mfma_f32_32x32x16_bf16 v[0:15], a[200:203], v[72:75], v[0:15]
    s_nop 0
    ds_write_b128 v193, v[32:35] offset:0
    ds_write_b128 v193, v[36:39] offset:1024
    v_mul_f32 v178, v246, v178
    v_mul_f32 v179, v246, v179
    v_mfma_f32_32x32x16_bf16 v[0:15], a[208:211], v[80:83], v[0:15]
    ds_write_b128 v193, v[40:43] offset:2048
    ds_write_b128 v193, v[44:47] offset:3072
    v_mfma_f32_32x32x16_bf16 v[0:15], a[216:219], v[88:91], v[0:15]
    s_waitcnt lgkmcnt(0)
    s_barrier
    ds_read_b128 v[64:67], v195 offset:0
    ds_read_b128 v[80:83], v195 offset:4096
    ds_read_b128 v[96:99], v195 offset:8192
    ds_read_b128 v[68:71], v195 offset:1024
    ds_read_b128 v[84:87], v195 offset:5120
    s_nop 4
    v_pk_fma_f32 v[0:1], v[0:1], v[246:247], v[164:165] op_sel:[0,1,0] op_sel_hi:[1,1,1]
    v_pk_fma_f32 v[2:3], v[2:3], v[246:247], v[166:167] op_sel:[0,1,0] op_sel_hi:[1,1,1]
    ds_read_b128 v[100:103], v195 offset:9216
    v_pk_fma_f32 v[4:5], v[4:5], v[246:247], v[168:169] op_sel:[0,1,0] op_sel_hi:[1,1,1]
    v_pk_fma_f32 v[6:7], v[6:7], v[246:247], v[170:171] op_sel:[0,1,0] op_sel_hi:[1,1,1]
    ds_read_b128 v[72:75], v195 offset:2048
    v_pk_fma_f32 v[8:9], v[8:9], v[246:247], v[172:173] op_sel:[0,1,0] op_sel_hi:[1,1,1]
    v_pk_fma_f32 v[10:11], v[10:11], v[246:247], v[174:175] op_sel:[0,1,0] op_sel_hi:[1,1,1]
    ds_read_b128 v[88:91], v195 offset:6144
    v_pk_fma_f32 v[12:13], v[12:13], v[246:247], v[176:177] op_sel:[0,1,0] op_sel_hi:[1,1,1]
    v_pk_fma_f32 v[14:15], v[14:15], v[246:247], v[178:179] op_sel:[0,1,0] op_sel_hi:[1,1,1]
    ds_read_b128 v[104:107], v195 offset:10240
    s_waitcnt lgkmcnt(6)
    v_pk_fma_f32 v[0:1], v[64:65], v[246:247], v[0:1] op_sel:[0,1,0] op_sel_hi:[1,1,1]
    v_pk_fma_f32 v[2:3], v[66:67], v[246:247], v[2:3] op_sel:[0,1,0] op_sel_hi:[1,1,1]
    ds_read_b128 v[76:79], v195 offset:3072
    v_pk_fma_f32 v[0:1], v[80:81], v[246:247], v[0:1] op_sel:[0,1,0] op_sel_hi:[1,1,1]
    v_pk_fma_f32 v[2:3], v[82:83], v[246:247], v[2:3] op_sel:[0,1,0] op_sel_hi:[1,1,1]
    v_pk_fma_f32 v[0:1], v[96:97], v[246:247], v[0:1] op_sel:[0,1,0] op_sel_hi:[1,1,1]
    ds_read_b128 v[92:95], v195 offset:7168
    v_pk_fma_f32 v[2:3], v[98:99], v[246:247], v[2:3] op_sel:[0,1,0] op_sel_hi:[1,1,1]
    v_cvt_pk_bf16_f32 v16, v0, v1
    v_cvt_pk_bf16_f32 v17, v2, v3
    ds_read_b128 v[108:111], v195 offset:11264
    s_waitcnt lgkmcnt(6)
    v_pk_fma_f32 v[4:5], v[68:69], v[246:247], v[4:5] op_sel:[0,1,0] op_sel_hi:[1,1,1]
    v_pk_fma_f32 v[6:7], v[70:71], v[246:247], v[6:7] op_sel:[0,1,0] op_sel_hi:[1,1,1]
    v_pk_fma_f32 v[4:5], v[84:85], v[246:247], v[4:5] op_sel:[0,1,0] op_sel_hi:[1,1,1]
    v_pk_fma_f32 v[6:7], v[86:87], v[246:247], v[6:7] op_sel:[0,1,0] op_sel_hi:[1,1,1]
    v_pk_fma_f32 v[4:5], v[100:101], v[246:247], v[4:5] op_sel:[0,1,0] op_sel_hi:[1,1,1]
    v_pk_fma_f32 v[6:7], v[102:103], v[246:247], v[6:7] op_sel:[0,1,0] op_sel_hi:[1,1,1]
    v_cvt_pk_bf16_f32 v18, v4, v5
    v_cvt_pk_bf16_f32 v19, v6, v7
    s_nop 0
    v_permlane32_swap_b32 v16, v18
    v_permlane32_swap_b32 v17, v19
    buffer_store_dwordx4 v[16:19], v196, s[52:55], 0 offen offset:0
    s_waitcnt lgkmcnt(0)
    v_pk_fma_f32 v[8:9], v[72:73], v[246:247], v[8:9] op_sel:[0,1,0] op_sel_hi:[1,1,1]
    v_pk_fma_f32 v[10:11], v[74:75], v[246:247], v[10:11] op_sel:[0,1,0] op_sel_hi:[1,1,1]
    v_pk_fma_f32 v[8:9], v[88:89], v[246:247], v[8:9] op_sel:[0,1,0] op_sel_hi:[1,1,1]
    v_pk_fma_f32 v[10:11], v[90:91], v[246:247], v[10:11] op_sel:[0,1,0] op_sel_hi:[1,1,1]
    v_pk_fma_f32 v[8:9], v[104:105], v[246:247], v[8:9] op_sel:[0,1,0] op_sel_hi:[1,1,1]
    v_pk_fma_f32 v[10:11], v[106:107], v[246:247], v[10:11] op_sel:[0,1,0] op_sel_hi:[1,1,1]
    v_cvt_pk_bf16_f32 v20, v8, v9
    v_cvt_pk_bf16_f32 v21, v10, v11
    v_pk_fma_f32 v[12:13], v[76:77], v[246:247], v[12:13] op_sel:[0,1,0] op_sel_hi:[1,1,1]
    v_pk_fma_f32 v[14:15], v[78:79], v[246:247], v[14:15] op_sel:[0,1,0] op_sel_hi:[1,1,1]
    v_pk_fma_f32 v[12:13], v[92:93], v[246:247], v[12:13] op_sel:[0,1,0] op_sel_hi:[1,1,1]
    v_pk_fma_f32 v[14:15], v[94:95], v[246:247], v[14:15] op_sel:[0,1,0] op_sel_hi:[1,1,1]
    v_pk_fma_f32 v[12:13], v[108:109], v[246:247], v[12:13] op_sel:[0,1,0] op_sel_hi:[1,1,1]
    v_pk_fma_f32 v[14:15], v[110:111], v[246:247], v[14:15] op_sel:[0,1,0] op_sel_hi:[1,1,1]
    v_cvt_pk_bf16_f32 v22, v12, v13
    v_cvt_pk_bf16_f32 v23, v14, v15
    s_nop 0
    v_permlane32_swap_b32 v20, v22
    v_permlane32_swap_b32 v21, v23
    buffer_store_dwordx4 v[20:23], v196, s[52:55], 0 offen offset:32
    s_endpgm
L_spare_2:
    s_waitcnt lgkmcnt(0)
    s_mov_b64 s[36:37], s[4:5]
    s_mov_b64 s[40:41], s[20:21]
    s_mov_b64 s[44:45], s[22:23]
    s_mov_b32 s76, s69
    s_mov_b32 s48, s32
    s_mov_b32 s49, s33
    s_mov_b32 s50, 0x10000000
    s_mov_b32 s51, 0x00020000
    s_mov_b32 s52, s28
    s_mov_b32 s53, s29
    s_mov_b32 s54, 0x200000
    s_mov_b32 s55, 0x00020000
    s_mov_b32 s60, s30
    s_mov_b32 s61, s31
    s_mov_b32 s62, 0x100
    s_mov_b32 s63, 0x00020000
    s_cmp_lg_u32 s76, 0
    s_cbranch_scc1 L_noclr_19
    v_mov_b32 v4, 0
    v_mov_b32 v5, 0
    v_mov_b32 v6, 0
    v_mov_b32 v7, 0
    v_lshlrev_b32 v1, 4, v0
    s_mov_b32 s80, 0
    buffer_store_dwordx4 v[4:7], v1, s[48:51], s80 offen sc1
    s_mov_b32 s80, 4096
    buffer_store_dwordx4 v[4:7], v1, s[48:51], s80 offen sc1
    s_mov_b32 s80, 8192
    buffer_store_dwordx4 v[4:7], v1, s[48:51], s80 offen sc1
    s_mov_b32 s80, 12288
    buffer_store_dwordx4 v[4:7], v1, s[48:51], s80 offen sc1
    s_mov_b32 s80, 16384
    buffer_store_dwordx4 v[4:7], v1, s[48:51], s80 offen sc1
    s_mov_b32 s80, 20480
    buffer_store_dwordx4 v[4:7], v1, s[48:51], s80 offen sc1
    s_mov_b32 s80, 24576
    buffer_store_dwordx4 v[4:7], v1, s[48:51], s80 offen sc1
    s_mov_b32 s80, 28672
    buffer_store_dwordx4 v[4:7], v1, s[48:51], s80 offen sc1
L_noclr_19:
    s_mov_b32 s56, s24
    s_mov_b32 s57, s25
    s_mov_b32 s58, 0x1c0000
    s_mov_b32 s59, 0x00020000
    s_lshr_b32 s84, s76, 3
    s_lshl_b32 s84, s84, 2
    s_add_u32 s84, s84, s66
    s_mul_i32 s84, s84, 114688
    s_and_b32 s85, s76, 7
    s_lshl_b32 s85, s85, 7
    s_add_u32 s84, s84, s85
    v_lshrrev_b32 v140, 3, v255
    v_and_b32 v141, 7, v255
    v_bfe_u32 v142, v255, 4, 1
    v_lshlrev_b32 v142, 2, v142
    v_xor_b32 v142, v141, v142
    v_lshlrev_b32 v142, 4, v142
    v_lshl_add_u32 v143, v140, 10, v142
    s_mul_i32 s75, s66, 14336
    s_add_u32 s75, s75, 0
    s_add_u32 m0, s75, 0
    s_nop 0
    buffer_load_dwordx4 v143, s[56:59], s84 offen  lds
    s_add_u32 s84, s84, 8192
    s_add_u32 m0, s75, 1024
    s_nop 0
    buffer_load_dwordx4 v143, s[56:59], s84 offen  lds
    s_add_u32 s84, s84, 8192
    s_add_u32 m0, s75, 2048
    s_nop 0
    buffer_load_dwordx4 v143, s[56:59], s84 offen  lds
    s_add_u32 s84, s84, 8192
    s_add_u32 m0, s75, 3072
    s_nop 0
    buffer_load_dwordx4 v143, s[56:59], s84 offen  lds
    s_add_u32 s84, s84, 8192
    s_add_u32 m0, s75, 4096
    s_nop 0
    buffer_load_dwordx4 v143, s[56:59], s84 offen  lds
    s_add_u32 s84, s84, 8192
    s_add_u32 m0, s75, 5120
    s_nop 0
    buffer_load_dwordx4 v143, s[56:59], s84 offen  lds
    s_add_u32 s84, s84, 8192
    s_add_u32 m0, s75, 6144
    s_nop 0
    buffer_load_dwordx4 v143, s[56:59], s84 offen  lds
    s_add_u32 s84, s84, 8192
    s_add_u32 m0, s75, 7168
    s_nop 0
    buffer_load_dwordx4 v143, s[56:59], s84 offen  lds
    s_add_u32 s84, s84, 8192
    s_add_u32 m0, s75, 8192
    s_nop 0
    buffer_load_dwordx4 v143, s[56:59], s84 offen  lds
    s_add_u32 s84, s84, 8192
    s_add_u32 m0, s75, 9216
    s_nop 0
    buffer_load_dwordx4 v143, s[56:59], s84 offen  lds
    s_add_u32 s84, s84, 8192
    s_add_u32 m0, s75, 10240
    s_nop 0
    buffer_load_dwordx4 v143, s[56:59], s84 offen  lds
    s_add_u32 s84, s84, 8192
    s_add_u32 m0, s75, 11264
    s_nop 0
    buffer_load_dwordx4 v143, s[56:59], s84 offen  lds
    s_add_u32 s84, s84, 8192
    s_add_u32 m0, s75, 12288
    s_nop 0
    buffer_load_dwordx4 v143, s[56:59], s84 offen  lds
    s_add_u32 s84, s84, 8192
    s_add_u32 m0, s75, 13312
    s_nop 0
    buffer_load_dwordx4 v143, s[56:59], s84 offen  lds
    s_lshl_b32 s80, s77, 2
    s_add_u32 s80, s80, s66
    s_lshl_b32 s81, s80, 7
    v_lshl_add_u32 v192, v255, 1, s81
    s_lshr_b32 s80, s80, 1
    s_lshl_b32 s80, s80, 1
    v_mov_b32 v193, s80
    global_load_short_d16_hi v196, v192, s[6:7]
    global_load_short_d16_hi v197, v192, s[8:9]
    global_load_short_d16_hi v198, v192, s[10:11]
    global_load_short_d16_hi v199, v192, s[12:13]
    global_load_short_d16_hi v200, v193, s[14:15]
    global_load_short_d16_hi v201, v193, s[16:17]
    s_mov_b32 s40, s26
    s_mov_b32 s41, s27
    s_mov_b32 s42, 0x400
    s_mov_b32 s43, 0x00020000
    s_lshl_b32 s83, s66, 10
    s_add_u32 m0, s83, 131072
    v_lshlrev_b32 v5, 4, v255
    buffer_load_dwordx4 v5, s[40:43], 0 offen lds
    s_cmp_eq_u32 s66, 0
    s_cselect_b64 s[14:15], -1, 0
    v_mov_b32 v238, 1
    v_mov_b32 v239, 0
    s_lshl_b32 s80, s66, 3
    s_add_u32 s80, s80, s70
    s_add_u32 s80, s80, 192
    s_lshl_b32 s80, s80, 7
    v_and_b32 v192, 3, v255
    v_lshl_add_u32 v240, v192, 2, s80
    v_lshlrev_b32 v192, 3, v255
    v_add_u32 v241, 28672, v192
    s_lshl_b32 s80, s69, 2
    s_add_u32 s80, s80, s66
    s_lshl_b32 s80, s80, 7
    v_min_u32 v192, 6, v255
    v_lshl_add_u32 v242, v192, 2, s80
    s_add_u32 s80, s69, 192
    s_lshl_b32 s80, s80, 7
    s_add_u32 s80, s80, 16
    v_and_b32 v192, 3, v255
    v_lshl_add_u32 v192, v192, 2, s80
    v_cmp_gt_u32 vcc, 32, v255
    s_nop 1
    v_cndmask_b32 v242, v192, v242, vcc
    s_lshr_b32 s80, s69, 4
    s_lshl_b32 s80, s80, 5
    s_lshl_b32 s81, s70, 2
    s_add_u32 s80, s80, s81
    s_and_b32 s81, s66, 1
    s_lshl_b32 s81, s81, 1
    s_add_u32 s80, s80, s81
    s_add_u32 s80, s80, 128
    s_lshl_b32 s80, s80, 7
    v_and_b32 v192, 15, v255
    v_lshl_add_u32 v243, v192, 2, s80
    v_bfe_u32 v192, v255, 4, 1
    v_lshl_add_u32 v243, v192, 7, v243
    s_lshl_b32 s80, s77, 1
    s_lshr_b32 s81, s66, 1
    s_add_u32 s80, s80, s81
    s_and_b32 s81, s80, 15
    s_lshr_b32 s80, s80, 4
    s_and_b32 s82, s66, 1
    s_lshl_b32 s82, s82, 5
    s_add_u32 s80, s80, s82
    s_add_u32 s80, s80, 128
    s_lshl_b32 s80, s80, 5
    s_add_u32 s80, s80, s81
    s_lshl_b32 s79, s80, 2
    s_lshl_b32 s80, s76, 2
    s_add_u32 s80, s80, s66
    s_lshl_b32 s80, s80, 7
    s_add_u32 s78, s80, 0x8000
    s_mov_b32 s8, 0
    s_add_u32 s80, s76, 192
    s_lshl_b32 s80, s80, 5
    s_add_u32 s80, s80, s66
    s_lshl_b32 s11, s80, 2
    s_add_u32 s81, s66, 224
    s_lshl_b32 s81, s81, 5
    s_add_u32 s81, s81, s76
    s_lshl_b32 s12, s81, 2
    s_cmp_lg_u32 s76, 0
    s_cbranch_scc1 L_nogo_20
    s_waitcnt vmcnt(21)
    s_barrier
    s_cmp_lg_u32 s66, 0
    s_cbranch_scc1 L_nogo_20
    s_mov_b64 exec, 1
    buffer_store_dword v238, off, s[60:63], 0 sc1
    s_mov_b64 exec, -1
L_nogo_20:
    v_lshrrev_b32 v2, 5, v255
    v_bfe_u32 v1, v255, 2, 2
    v_lshl_add_u32 v1, v2, 3, v1
    v_bfe_u32 v2, v255, 4, 1
    v_bfe_u32 v3, v255, 1, 1
    v_lshl_add_u32 v2, v2, 1, v3
    v_bfe_u32 v3, v255, 3, 1
    v_lshl_add_u32 v2, v3, 2, v2
    v_and_b32 v3, 1, v255
    v_lshlrev_b32 v3, 3, v3
    v_lshl_add_u32 v3, v2, 4, v3
    v_lshl_add_u32 v3, v1, 7, v3
    v_add_u32 v6, s75, v3
    v_xor_b32 v7, 64, v6
    v_lshlrev_b32 v14, 4, v255
    s_and_b32 s80, s76, 7
    s_lshl_b32 s80, s80, 2
    s_lshr_b32 s81, s76, 3
    s_add_u32 s80, s80, s81
    s_lshl_b32 s80, s80, 2
    s_add_u32 s80, s80, s66
    s_mul_i32 s80, s80, 14336
    s_add_u32 s85, s80, 1048576
    s_waitcnt vmcnt(19)
    ds_read_b64_tr_b16 v[16:17], v6 offset:0
    ds_read_b64_tr_b16 v[18:19], v6 offset:512
    ds_read_b64_tr_b16 v[20:21], v7 offset:0
    ds_read_b64_tr_b16 v[22:23], v7 offset:512
    s_waitcnt vmcnt(17)
    ds_read_b64_tr_b16 v[24:25], v6 offset:2048
    ds_read_b64_tr_b16 v[26:27], v6 offset:2560
    ds_read_b64_tr_b16 v[28:29], v7 offset:2048
    ds_read_b64_tr_b16 v[30:31], v7 offset:2560
    s_waitcnt lgkmcnt(6)
    buffer_store_dwordx4 v[16:19], v14, s[48:51], s85 offen offset:0 sc1
    s_waitcnt lgkmcnt(4)
    buffer_store_dwordx4 v[20:23], v14, s[48:51], s85 offen offset:1024 sc1
    s_waitcnt vmcnt(17)
    ds_read_b64_tr_b16 v[32:33], v6 offset:4096
    ds_read_b64_tr_b16 v[34:35], v6 offset:4608
    ds_read_b64_tr_b16 v[36:37], v7 offset:4096
    ds_read_b64_tr_b16 v[38:39], v7 offset:4608
    s_waitcnt lgkmcnt(6)
    buffer_store_dwordx4 v[24:27], v14, s[48:51], s85 offen offset:2048 sc1
    s_waitcnt lgkmcnt(4)
    buffer_store_dwordx4 v[28:31], v14, s[48:51], s85 offen offset:3072 sc1
    s_add_u32 s85, s85, 4096
    s_waitcnt vmcnt(17)
    ds_read_b64_tr_b16 v[40:41], v6 offset:6144
    ds_read_b64_tr_b16 v[42:43], v6 offset:6656
    ds_read_b64_tr_b16 v[44:45], v7 offset:6144
    ds_read_b64_tr_b16 v[46:47], v7 offset:6656
    s_waitcnt lgkmcnt(6)
    buffer_store_dwordx4 v[32:35], v14, s[48:51], s85 offen offset:0 sc1
    s_waitcnt lgkmcnt(4)
    buffer_store_dwordx4 v[36:39], v14, s[48:51], s85 offen offset:1024 sc1
    s_waitcnt vmcnt(17)
    ds_read_b64_tr_b16 v[48:49], v6 offset:8192
    ds_read_b64_tr_b16 v[50:51], v6 offset:8704
    ds_read_b64_tr_b16 v[52:53], v7 offset:8192
    ds_read_b64_tr_b16 v[54:55], v7 offset:8704
    s_waitcnt lgkmcnt(6)
    buffer_store_dwordx4 v[40:43], v14, s[48:51], s85 offen offset:2048 sc1
    s_waitcnt lgkmcnt(4)
    buffer_store_dwordx4 v[44:47], v14, s[48:51], s85 offen offset:3072 sc1
    s_add_u32 s85, s85, 4096
    s_waitcnt vmcnt(17)
    ds_read_b64_tr_b16 v[56:57], v6 offset:10240
    ds_read_b64_tr_b16 v[58:59], v6 offset:10752
    ds_read_b64_tr_b16 v[60:61], v7 offset:10240
    ds_read_b64_tr_b16 v[62:63], v7 offset:10752
    s_waitcnt lgkmcnt(6)
    buffer_store_dwordx4 v[48:51], v14, s[48:51], s85 offen offset:0 sc1
    s_waitcnt lgkmcnt(4)
    buffer_store_dwordx4 v[52:55], v14, s[48:51], s85 offen offset:1024 sc1
    s_waitcnt vmcnt(17)
    ds_read_b64_tr_b16 v[64:65], v6 offset:12288
    ds_read_b64_tr_b16 v[66:67], v6 offset:12800
    ds_read_b64_tr_b16 v[68:69], v7 offset:12288
    ds_read_b64_tr_b16 v[70:71], v7 offset:12800
    s_waitcnt lgkmcnt(6)
    buffer_store_dwordx4 v[56:59], v14, s[48:51], s85 offen offset:2048 sc1
    s_waitcnt lgkmcnt(4)
    buffer_store_dwordx4 v[60:63], v14, s[48:51], s85 offen offset:3072 sc1
    s_add_u32 s85, s85, 4096
    s_waitcnt lgkmcnt(2)
    buffer_store_dwordx4 v[64:67], v14, s[48:51], s85 offen offset:0 sc1
    s_waitcnt lgkmcnt(0)
    buffer_store_dwordx4 v[68:71], v14, s[48:51], s85 offen offset:1024 sc1
    buffer_load_dword v244, v239, s[60:63], 0 offen sc1
    s_lshl_b32 s81, s66, 2
    s_and_b32 s81, s81, 7
    v_xor_b32 v1, s81, v255
    v_lshlrev_b32 v10, 4, v1
    v_xor_b32 v11, 16, v10
    v_xor_b32 v12, 32, v10
    v_xor_b32 v13, 48, v10
    s_lshl_b32 s80, s76, 2
    s_add_u32 s80, s80, s66
    s_lshl_b32 s72, s80, 14
    s_mul_i32 s74, s66, 18432
    s_add_u32 m0, s74, 57344
    s_nop 0
    buffer_load_dwordx4 v10, s[36:39], s72 offen  lds
    s_add_u32 s72, s72, 1024
    s_add_u32 m0, s74, 58496
    s_nop 0
    buffer_load_dwordx4 v10, s[36:39], s72 offen  lds
    s_add_u32 s72, s72, 1024
    s_add_u32 m0, s74, 59648
    s_nop 0
    buffer_load_dwordx4 v11, s[36:39], s72 offen  lds
    s_add_u32 s72, s72, 1024
    s_add_u32 m0, s74, 60800
    s_nop 0
    buffer_load_dwordx4 v11, s[36:39], s72 offen  lds
    s_add_u32 s72, s72, 1024
    s_add_u32 m0, s74, 61952
    s_nop 0
    buffer_load_dwordx4 v10, s[36:39], s72 offen  lds
    s_add_u32 s72, s72, 1024
    s_add_u32 m0, s74, 63104
    s_nop 0
    buffer_load_dwordx4 v10, s[36:39], s72 offen  lds
    s_lshr_b32 s80, s66, 1
    s_and_b32 s81, s66, 1
    s_mul_i32 s82, s80, 2064
    s_add_u32 s82, s82, 159056
    s_lshl_b32 s83, s81, 6
    s_sub_u32 s83, 127, s83
    v_sub_u32 v192, s83, v255
    v_lshlrev_b32 v193, 4, v192
    v_cvt_f32_u32 v195, v193
    v_cvt_pk_bf16_f32 v195, v195, v195
    v_and_b32 v195, 0xffff, v195
    v_subrev_u32 v195, 17024, v195
    v_min_i32 v234, 128, v193
    v_max_i32 v195, v195, v234
    v_lshl_add_u32 v209, v195, 1, s82
    v_subrev_u32 v194, 1, v193
    v_max_i32 v194, 0, v194
    v_cvt_f32_u32 v195, v194
    v_cvt_pk_bf16_f32 v195, v195, v195
    v_and_b32 v195, 0xffff, v195
    v_subrev_u32 v195, 17024, v195
    v_min_i32 v234, 128, v194
    v_max_i32 v195, v195, v234
    v_lshl_add_u32 v218, v195, 1, s82
    s_add_u32 s83, s82, 2048
    v_mov_b32 v194, s83
    v_cmp_eq_u32 vcc, 0, v192
    s_nop 1
    v_cndmask_b32 v218, v218, v194, vcc
    v_ffbh_u32 v194, v192
    v_min_u32 v194, 28, v194
    v_sub_u32 v194, 28, v194
    v_lshlrev_b32 v194, 3, v194
    s_mov_b32 s83, 0x2
    v_bfe_u32 v195, s83, v194, 8
    v_add_u32 v217, v209, v195
    s_mov_b32 s83, 0x204
    v_bfe_u32 v195, s83, v194, 8
    v_add_u32 v208, v209, v195
    s_mov_b32 s83, 0x20406
    v_bfe_u32 v195, s83, v194, 8
    v_add_u32 v216, v209, v195
    s_mov_b32 s83, 0x20408
    v_bfe_u32 v195, s83, v194, 8
    v_add_u32 v207, v209, v195
    s_mov_b32 s83, 0x202040a
    v_bfe_u32 v195, s83, v194, 8
    v_add_u32 v215, v209, v195
    s_mov_b32 s83, 0x204060c
    v_bfe_u32 v195, s83, v194, 8
    v_add_u32 v206, v209, v195
    s_mov_b32 s83, 0x204080e
    v_bfe_u32 v195, s83, v194, 8
    v_add_u32 v214, v209, v195
    s_mov_b32 s83, 0x2040810
    v_bfe_u32 v195, s83, v194, 8
    v_add_u32 v205, v209, v195
    s_mov_b32 s83, 0x2040812
    v_bfe_u32 v195, s83, v194, 8
    v_add_u32 v213, v209, v195
    s_mov_b32 s83, 0x2040a14
    v_bfe_u32 v195, s83, v194, 8
    v_add_u32 v204, v209, v195
    s_mov_b32 s83, 0x2060c16
    v_bfe_u32 v195, s83, v194, 8
    v_add_u32 v212, v209, v195
    s_mov_b32 s83, 0x4060c18
    v_bfe_u32 v195, s83, v194, 8
    v_add_u32 v203, v209, v195
    s_mov_b32 s83, 0x4060c1a
    v_bfe_u32 v195, s83, v194, 8
    v_add_u32 v211, v209, v195
    s_mov_b32 s83, 0x4080e1c
    v_bfe_u32 v195, s83, v194, 8
    v_add_u32 v202, v209, v195
    s_mov_b32 s83, 0x408101e
    v_bfe_u32 v195, s83, v194, 8
    v_add_u32 v210, v209, v195
    v_and_b32 v192, 15, v255
    s_lshl_b32 s83, s81, 4
    v_add_u32 v192, s83, v192
    v_lshrrev_b32 v193, 4, v255
    v_lshlrev_b32 v194, 3, v193
    v_lshl_add_u32 v194, v192, 4, v194
    v_lshlrev_b32 v195, 3, v192
    v_add_u32 v195, 512, v195
    v_cmp_eq_u32 vcc, 2, v193
    s_nop 1
    v_cndmask_b32 v194, v194, v195, vcc
    v_lshlrev_b32 v195, 2, v192
    v_add_u32 v195, 768, v195
    v_mov_b32 v234, 4
    v_mov_b32 v220, 128
    v_cmp_eq_u32 vcc, 3, v193
    s_nop 1
    v_cndmask_b32 v194, v194, v195, vcc
    v_cndmask_b32 v234, v234, v220, vcc
    v_add_u32 v219, s82, v194
    v_add_u32 v220, v219, v234
    v_lshlrev_b32 v194, 8, v193
    v_lshl_add_u32 v194, v192, 1, v194
    v_add_u32 v221, s82, v194
    v_or_b32 v194, v192, v193
    v_mov_b32 v195, 0
    v_cmp_eq_u32 vcc, 0, v194
    s_nop 1
    v_cndmask_b32 v223, v195, 1.0, vcc
    v_lshrrev_b32 v192, 5, v255
    v_mul_u32_u24 v192, 4672, v192
    v_and_b32 v193, 31, v255
    v_lshl_add_u32 v192, v193, 4, v192
    v_add_u32 v192, 147712, v192
    v_bfe_u32 v193, v255, 1, 2
    v_mul_u32_u24 v193, 4160, v193
    v_and_b32 v194, 1, v255
    v_lshl_add_u32 v193, v194, 4, v193
    v_add_u32 v193, 135168, v193
    v_mul_u32_u24 v194, 2064, v194
    v_add_u32 v194, 161104, v194
    v_and_b32 v195, 8, v255
    v_cmp_eq_u32 vcc, 0, v195
    s_nop 1
    v_cndmask_b32 v193, v194, v193, vcc
    s_cmp_eq_u32 s66, 0
    s_cselect_b64 vcc, -1, 0
    v_cndmask_b32 v222, v193, v192, vcc
    s_waitcnt vmcnt(6)
    v_cmp_ne_u32 vcc, 1, v244
    s_nop 4
    s_cbranch_vccnz L_slow_21
L_ret_22:
    s_mov_b64 exec, 1
    buffer_store_dword v238, off, s[48:51], s11 sc1
    s_mov_b64 exec, -1
    s_add_u32 s72, s72, 1024
    s_add_u32 m0, s74, 64256
    s_nop 0
    buffer_load_dwordx4 v11, s[36:39], s72 offen  lds
    s_add_u32 s72, s72, 1024
    s_add_u32 m0, s74, 65408
    s_nop 0
    buffer_load_dwordx4 v11, s[36:39], s72 offen  lds
    s_add_u32 s72, s72, 1024
    s_add_u32 m0, s74, 66560
    s_nop 0
    buffer_load_dwordx4 v12, s[36:39], s72 offen  lds
    s_add_u32 s72, s72, 1024
    s_add_u32 m0, s74, 67712
    s_nop 0
    buffer_load_dwordx4 v12, s[36:39], s72 offen  lds
    s_add_u32 s72, s72, 1024
    s_add_u32 m0, s74, 68864
    s_nop 0
    buffer_load_dwordx4 v13, s[36:39], s72 offen  lds
    s_add_u32 s72, s72, 1024
    s_add_u32 m0, s74, 70016
    s_nop 0
    buffer_load_dwordx4 v13, s[36:39], s72 offen  lds
    s_add_u32 s72, s72, 1024
    s_add_u32 m0, s74, 71168
    s_nop 0
    buffer_load_dwordx4 v12, s[36:39], s72 offen  lds
    s_add_u32 s72, s72, 1024
    s_add_u32 m0, s74, 72320
    s_nop 0
    buffer_load_dwordx4 v12, s[36:39], s72 offen  lds
    s_add_u32 s72, s72, 1024
    s_add_u32 m0, s74, 73472
    s_nop 0
    buffer_load_dwordx4 v13, s[36:39], s72 offen  lds
    s_add_u32 s72, s72, 1024
    s_add_u32 m0, s74, 74624
    s_nop 0
    buffer_load_dwordx4 v13, s[36:39], s72 offen  lds
    v_and_b32 v1, 3, v255
    v_lshrrev_b32 v2, 5, v255
    v_lshl_add_u32 v2, v2, 2, v1
    v_bfe_u32 v3, v255, 2, 2
    v_lshl_add_u32 v2, v2, 3, v3
    v_mul_u32_u24 v2, 1152, v2
    v_bfe_u32 v3, v255, 3, 1
    v_lshl_add_u32 v1, v1, 1, v3
    v_lshl_add_u32 v2, v1, 4, v2
    v_bfe_u32 v3, v255, 4, 1
    v_lshl_add_u32 v2, v3, 3, v2
    s_lshl_b32 s80, s66, 8
    s_add_u32 s80, s80, 57344
    v_add_u32 v72, s80, v2
    v_xor_b32 v73, 16, v72
    v_xor_b32 v74, 32, v72
    v_xor_b32 v75, 48, v72
    v_xor_b32 v76, 64, v72
    v_xor_b32 v77, 80, v72
    v_xor_b32 v78, 96, v72
    v_xor_b32 v79, 112, v72
    v_and_b32 v1, 15, v255
    v_lshlrev_b32 v1, 4, v1
    v_lshrrev_b32 v2, 5, v255
    v_lshl_add_u32 v1, v2, 8, v1
    v_lshl_add_u32 v14, v3, 14, v1
    s_lshl_b32 s80, s66, 19
    s_lshl_b32 s81, s76, 9
    s_add_u32 s80, s80, s81
    s_add_u32 s85, s80, 3145728
    s_waitcnt vmcnt(0)
    s_barrier
    ds_read_b64_tr_b16 v[16:17], v72 offset:0
    ds_read_b64_tr_b16 v[18:19], v72 offset:4608
    ds_read_b64_tr_b16 v[20:21], v73 offset:0
    ds_read_b64_tr_b16 v[22:23], v73 offset:4608
    ds_read_b64_tr_b16 v[24:25], v74 offset:0
    ds_read_b64_tr_b16 v[26:27], v74 offset:4608
    ds_read_b64_tr_b16 v[28:29], v75 offset:0
    ds_read_b64_tr_b16 v[30:31], v75 offset:4608
    ds_read_b64_tr_b16 v[32:33], v76 offset:0
    ds_read_b64_tr_b16 v[34:35], v76 offset:4608
    ds_read_b64_tr_b16 v[36:37], v77 offset:0
    ds_read_b64_tr_b16 v[38:39], v77 offset:4608
    ds_read_b64_tr_b16 v[40:41], v78 offset:0
    ds_read_b64_tr_b16 v[42:43], v78 offset:4608
    ds_read_b64_tr_b16 v[44:45], v79 offset:0
    ds_read_b64_tr_b16 v[46:47], v79 offset:4608
    ds_read_b64_tr_b16 v[80:81], v72 offset:128
    ds_read_b64_tr_b16 v[82:83], v72 offset:4736
    ds_read_b64_tr_b16 v[84:85], v73 offset:128
    ds_read_b64_tr_b16 v[86:87], v73 offset:4736
    ds_read_b64_tr_b16 v[88:89], v74 offset:128
    ds_read_b64_tr_b16 v[90:91], v74 offset:4736
    ds_read_b64_tr_b16 v[92:93], v75 offset:128
    ds_read_b64_tr_b16 v[94:95], v75 offset:4736
    ds_read_b64_tr_b16 v[96:97], v76 offset:128
    ds_read_b64_tr_b16 v[98:99], v76 offset:4736
    ds_read_b64_tr_b16 v[100:101], v77 offset:128
    ds_read_b64_tr_b16 v[102:103], v77 offset:4736
    ds_read_b64_tr_b16 v[104:105], v78 offset:128
    ds_read_b64_tr_b16 v[106:107], v78 offset:4736
    ds_read_b64_tr_b16 v[108:109], v79 offset:128
    ds_read_b64_tr_b16 v[110:111], v79 offset:4736
    s_waitcnt lgkmcnt(15)
    buffer_store_dwordx4 v[16:19], v14, s[48:51], s85 offen sc1
    s_add_u32 s85, s85, 32768
    buffer_store_dwordx4 v[20:23], v14, s[48:51], s85 offen sc1
    s_add_u32 s85, s85, 32768
    buffer_store_dwordx4 v[24:27], v14, s[48:51], s85 offen sc1
    s_add_u32 s85, s85, 32768
    buffer_store_dwordx4 v[28:31], v14, s[48:51], s85 offen sc1
    s_add_u32 s85, s85, 32768
    buffer_store_dwordx4 v[32:35], v14, s[48:51], s85 offen sc1
    s_add_u32 s85, s85, 32768
    buffer_store_dwordx4 v[36:39], v14, s[48:51], s85 offen sc1
    s_add_u32 s85, s85, 32768
    buffer_store_dwordx4 v[40:43], v14, s[48:51], s85 offen sc1
    s_add_u32 s85, s85, 32768
    buffer_store_dwordx4 v[44:47], v14, s[48:51], s85 offen sc1
    s_add_u32 s85, s85, 32768
    s_waitcnt lgkmcnt(14)
    buffer_store_dwordx4 v[80:83], v14, s[48:51], s85 offen sc1
    s_add_u32 s85, s85, 32768
    s_waitcnt lgkmcnt(12)
    buffer_store_dwordx4 v[84:87], v14, s[48:51], s85 offen sc1
    s_add_u32 s85, s85, 32768
    s_waitcnt lgkmcnt(10)
    buffer_store_dwordx4 v[88:91], v14, s[48:51], s85 offen sc1
    s_add_u32 s85, s85, 32768
    s_waitcnt lgkmcnt(8)
    buffer_store_dwordx4 v[92:95], v14, s[48:51], s85 offen sc1
    s_add_u32 s85, s85, 32768
    s_waitcnt lgkmcnt(6)
    buffer_store_dwordx4 v[96:99], v14, s[48:51], s85 offen sc1
    s_add_u32 s85, s85, 32768
    s_waitcnt lgkmcnt(4)
    buffer_store_dwordx4 v[100:103], v14, s[48:51], s85 offen sc1
    s_add_u32 s85, s85, 32768
    s_waitcnt lgkmcnt(2)
    buffer_store_dwordx4 v[104:107], v14, s[48:51], s85 offen sc1
    s_add_u32 s85, s85, 32768
    s_waitcnt lgkmcnt(0)
    buffer_store_dwordx4 v[108:111], v14, s[48:51], s85 offen sc1
    buffer_load_dword v253, v240, s[48:51], 0 offen sc1
    s_lshl_b32 s80, s70, 2
    s_add_u32 s80, s80, s66
    s_mul_i32 s80, s80, 57344
    s_add_u32 s80, s80, 1048576
    s_add_u32 s5, s80, 57344
    s_lshl_b32 s81, s8, 12
    s_add_u32 s4, s80, s81
    s_and_b32 s81, s66, 1
    s_lshl_b32 s81, s81, 10
    v_lshl_add_u32 v236, v255, 4, s81
    v_xor_b32 v237, 1024, v236
    s_lshl_b32 s80, s66, 4
    v_lshrrev_b32 v1, 2, v255
    v_add_u32 v1, s80, v1
    v_bfe_u32 v2, v1, 3, 2
    v_bfe_u32 v3, v1, 1, 1
    v_lshl_add_u32 v2, v2, 1, v3
    v_and_b32 v3, 3, v255
    v_xor_b32 v2, v2, v3
    v_mul_u32_u24 v8, 1152, v1
    v_lshl_add_u32 v8, v2, 4, v8
    v_add_u32 v8, 57344, v8
    v_xor_b32 v9, 64, v8
    s_lshl_b32 s83, s66, 10
    s_add_u32 s83, s83, 131072
    v_lshl_add_u32 v3, v3, 4, s83
    v_mov_b32 v10, 0
    v_mov_b32 v11, 0
    v_mov_b32 v12, 0
    v_mov_b32 v13, 0
    ds_read_b128 v[112:115], v8 offset:0
    ds_read_b128 v[116:119], v9 offset:0
    ds_read_b128 v[120:123], v8 offset:128
    ds_read_b128 v[124:127], v9 offset:128
    ds_read_b128 v[128:131], v8 offset:256
    ds_read_b128 v[132:135], v9 offset:256
    ds_read_b128 v[136:139], v8 offset:384
    ds_read_b128 v[140:143], v9 offset:384
    ds_read_b128 v[144:147], v8 offset:512
    ds_read_b128 v[148:151], v9 offset:512
    ds_read_b128 v[152:155], v8 offset:640
    ds_read_b128 v[156:159], v9 offset:640
    ds_read_b128 v[160:163], v8 offset:768
    ds_read_b128 v[164:167], v9 offset:768
    ds_read_b128 v[168:171], v8 offset:896
    ds_read_b128 v[172:175], v9 offset:896
    ds_read_b128 v[176:179], v3 offset:0
    ds_read_b128 v[180:183], v3 offset:64
    ds_read_b128 v[184:187], v3 offset:128
    ds_read_b128 v[188:191], v3 offset:192
    s_waitcnt lgkmcnt(3)
    v_dot2c_f32_bf16 v10, v112, v176
    v_dot2c_f32_bf16 v11, v113, v177
    v_dot2c_f32_bf16 v12, v114, v178
    v_dot2c_f32_bf16 v13, v115, v179
    ds_read_b128 v[176:179], v3 offset:256
    s_waitcnt lgkmcnt(3)
    v_dot2c_f32_bf16 v10, v116, v180
    v_dot2c_f32_bf16 v11, v117, v181
    v_dot2c_f32_bf16 v12, v118, v182
    v_dot2c_f32_bf16 v13, v119, v183
    ds_read_b128 v[180:183], v3 offset:320
    s_waitcnt lgkmcnt(3)
    v_dot2c_f32_bf16 v10, v120, v184
    v_dot2c_f32_bf16 v11, v121, v185
    v_dot2c_f32_bf16 v12, v122, v186
    v_dot2c_f32_bf16 v13, v123, v187
    ds_read_b128 v[184:187], v3 offset:384
    s_waitcnt lgkmcnt(3)
    v_dot2c_f32_bf16 v10, v124, v188
    v_dot2c_f32_bf16 v11, v125, v189
    v_dot2c_f32_bf16 v12, v126, v190
    v_dot2c_f32_bf16 v13, v127, v191
    ds_read_b128 v[188:191], v3 offset:448
    s_waitcnt lgkmcnt(3)
    v_dot2c_f32_bf16 v10, v128, v176
    v_dot2c_f32_bf16 v11, v129, v177
    v_dot2c_f32_bf16 v12, v130, v178
    v_dot2c_f32_bf16 v13, v131, v179
    ds_read_b128 v[176:179], v3 offset:512
    s_waitcnt lgkmcnt(3)
    v_dot2c_f32_bf16 v10, v132, v180
    v_dot2c_f32_bf16 v11, v133, v181
    v_dot2c_f32_bf16 v12, v134, v182
    v_dot2c_f32_bf16 v13, v135, v183
    ds_read_b128 v[180:183], v3 offset:576
    s_waitcnt lgkmcnt(3)
    v_dot2c_f32_bf16 v10, v136, v184
    v_dot2c_f32_bf16 v11, v137, v185
    v_dot2c_f32_bf16 v12, v138, v186
    v_dot2c_f32_bf16 v13, v139, v187
    ds_read_b128 v[184:187], v3 offset:640
    s_waitcnt lgkmcnt(3)
    v_dot2c_f32_bf16 v10, v140, v188
    v_dot2c_f32_bf16 v11, v141, v189
    v_dot2c_f32_bf16 v12, v142, v190
    v_dot2c_f32_bf16 v13, v143, v191
    ds_read_b128 v[188:191], v3 offset:704
    s_waitcnt lgkmcnt(3)
    v_dot2c_f32_bf16 v10, v144, v176
    v_dot2c_f32_bf16 v11, v145, v177
    v_dot2c_f32_bf16 v12, v146, v178
    v_dot2c_f32_bf16 v13, v147, v179
    ds_read_b128 v[176:179], v3 offset:768
    s_waitcnt lgkmcnt(3)
    v_dot2c_f32_bf16 v10, v148, v180
    v_dot2c_f32_bf16 v11, v149, v181
    v_dot2c_f32_bf16 v12, v150, v182
    v_dot2c_f32_bf16 v13, v151, v183
    ds_read_b128 v[180:183], v3 offset:832
    s_waitcnt lgkmcnt(3)
    v_dot2c_f32_bf16 v10, v152, v184
    v_dot2c_f32_bf16 v11, v153, v185
    v_dot2c_f32_bf16 v12, v154, v186
    v_dot2c_f32_bf16 v13, v155, v187
    ds_read_b128 v[184:187], v3 offset:896
    s_waitcnt lgkmcnt(3)
    v_dot2c_f32_bf16 v10, v156, v188
    v_dot2c_f32_bf16 v11, v157, v189
    v_dot2c_f32_bf16 v12, v158, v190
    v_dot2c_f32_bf16 v13, v159, v191
    ds_read_b128 v[188:191], v3 offset:960
    s_waitcnt lgkmcnt(3)
    v_dot2c_f32_bf16 v10, v160, v176
    v_dot2c_f32_bf16 v11, v161, v177
    v_dot2c_f32_bf16 v12, v162, v178
    v_dot2c_f32_bf16 v13, v163, v179
    s_waitcnt lgkmcnt(2)
    v_dot2c_f32_bf16 v10, v164, v180
    v_dot2c_f32_bf16 v11, v165, v181
    v_dot2c_f32_bf16 v12, v166, v182
    v_dot2c_f32_bf16 v13, v167, v183
    s_waitcnt lgkmcnt(1)
    v_dot2c_f32_bf16 v10, v168, v184
    v_dot2c_f32_bf16 v11, v169, v185
    v_dot2c_f32_bf16 v12, v170, v186
    v_dot2c_f32_bf16 v13, v171, v187
    s_waitcnt lgkmcnt(0)
    v_dot2c_f32_bf16 v10, v172, v188
    v_dot2c_f32_bf16 v11, v173, v189
    v_dot2c_f32_bf16 v12, v174, v190
    v_dot2c_f32_bf16 v13, v175, v191
    s_nop 0
    v_add_f32 v10, v10, v11
    s_nop 0
    v_add_f32 v12, v12, v13
    v_add_f32 v10, v10, v12
    s_nop 1
    v_add_f32_dpp v11, v10, v10 quad_perm:[1,0,3,2] row_mask:0xf bank_mask:0xf
    s_nop 1
    v_add_f32_dpp v10, v11, v11 quad_perm:[2,3,0,1] row_mask:0xf bank_mask:0xf
    v_cvt_pk_bf16_f32 v10, v10, v10
    v_and_b32 v10, 0xffff0000, v10
    v_mul_f32 v10, 0xbfb8aa3b, v10
    v_exp_f32 v10, v10
    s_nop 0
    v_add_f32 v10, 1.0, v10
    v_rcp_f32 v10, v10
    s_nop 0
    v_cvt_pk_bf16_f32 v10, v10, v10
    v_and_b32 v10, 0xffff0000, v10
    s_lshl_b32 s80, s76, 8
    s_add_u32 s80, s80, 5242880
    v_lshlrev_b32 v1, 2, v1
    s_waitcnt vmcnt(1)
    s_mov_b64 exec, 1
    buffer_store_dword v238, off, s[48:51], s12 sc1
    s_mov_b64 exec, -1
    buffer_store_dword v10, v1, s[48:51], s80 offen sc1
    s_waitcnt vmcnt(2)
    v_cmp_ne_u32 vcc, 1, v253
    s_nop 4
    s_cbranch_vccnz L_slow_24
L_ret_25:
    s_barrier
    s_mov_b32 s82, 0x3fb8aa3b
    s_lshr_b32 s80, s66, 1
    s_mul_i32 s81, s80, 2064
    s_add_u32 s81, s81, 161104
    v_mov_b32 v10, s81
    s_mul_i32 s80, s80, 65536
    s_and_b32 s81, s66, 1
    s_lshl_b32 s81, s81, 8
    s_add_u32 s80, s80, s81
    s_add_u32 s80, s80, 65536
    v_lshl_add_u32 v13, v255, 2, s80
    v_mov_b32 v11, 0
    v_mov_b32 v12, 0x3f80
    ds_write_b32 v10, v11
    ds_write_b32 v13, v12
    v_mul_f32 v0, 0x3fb8aa3b, v200
    v_mul_f32 v2, 0x3fb8aa3b, v196
    v_fma_f32 v1, v200, s82, -v0
    v_fma_f32 v3, v196, s82, -v2
    v_fmac_f32 v1, 0x32a57060, v200
    v_fmac_f32 v3, 0x32a57060, v196
    v_exp_f32 v0, v0
    v_exp_f32 v2, v2
    v_mul_f32 v1, 0x3f317218, v1
    v_mul_f32 v3, 0x3f317218, v3
    v_fmac_f32 v0, v0, v1
    v_fmac_f32 v2, v2, v3
    v_cvt_pk_bf16_f32 v0, v0, v0
    buffer_load_dwordx4 a[0:3], v236, s[48:51], s4 offen offset:0 sc1
    v_cvt_pk_bf16_f32 v2, v2, v2
    v_and_b32 v200, 0xffff0000, v0
    v_and_b32 v196, 0xffff0000, v2
    v_mul_f32 v4, v196, v200
    v_mul_f32 v5, v197, v200
    v_mul_f32 v6, v198, v200
    v_mul_f32 v7, v199, v200
    v_mul_f32 v4, 0xbfb8aa3b, v4
    v_mul_f32 v5, 0x3e22f983, v5
    v_add_f32 v16, v6, v6
    v_add_f32 v17, v7, v7
    v_mul_f32 v223, v223, v201
    buffer_load_dwordx4 a[4:7], v237, s[48:51], s4 offen offset:0 sc1
    v_mul_f32 v0, 8.0, v4
    v_mul_f32 v2, 256.0, v4
    v_exp_f32 v8, v4
    v_mul_f32 v1, 8.0, v5
    v_mul_f32 v3, 256.0, v5
    v_fract_f32 v9, v5
    v_exp_f32 v0, v0
    v_exp_f32 v2, v2
    v_cos_f32 v122, v9
    v_fract_f32 v1, v1
    v_fract_f32 v3, v3
    v_sin_f32 v123, v9
    buffer_load_dwordx4 a[8:11], v236, s[48:51], s4 offen offset:2048 sc1
    v_cos_f32 v60, v1
    v_cos_f32 v128, v3
    v_mul_f32 v122, v122, v8
    v_sin_f32 v61, v1
    v_sin_f32 v129, v3
    v_mul_f32 v123, v123, v8
    v_mul_f32 v60, v60, v0
    v_mul_f32 v128, v128, v2
    v_mul_f32 v61, v61, v0
    v_mul_f32 v129, v129, v2
    v_pk_mul_f32 v[62:63], v[60:61], v[60:61] op_sel:[0,0] op_sel_hi:[0,1]
    v_pk_mul_f32 v[124:125], v[122:123], v[122:123] op_sel:[0,0] op_sel_hi:[0,1]
    buffer_load_dwordx4 a[12:15], v237, s[48:51], s4 offen offset:2048 sc1
    s_add_u32 s4, s4, 4096
    v_pk_mul_f32 v[32:33], v[16:17], v[128:129] op_sel:[0,0] op_sel_hi:[0,1]
    v_pk_fma_f32 v[62:63], v[60:61], v[60:61], v[62:63] op_sel:[1,1,0] op_sel_hi:[1,0,1] neg_lo:[0,1,0]
    v_pk_fma_f32 v[124:125], v[122:123], v[122:123], v[124:125] op_sel:[1,1,0] op_sel_hi:[1,0,1] neg_lo:[0,1,0]
    v_pk_fma_f32 v[32:33], v[16:17], v[128:129], v[32:33] op_sel:[1,1,0] op_sel_hi:[1,0,1] neg_lo:[0,1,0]
    v_cvt_pk_bf16_f32 v130, v60, v61
    v_cvt_pk_bf16_f32 v131, v16, -v17
    v_pk_mul_f32 v[18:19], v[16:17], v[122:123] op_sel:[0,0] op_sel_hi:[0,1]
    ds_write_b32 v13, v130 offset:528
    ds_write_b32 v13, v131 offset:16896
    v_pk_fma_f32 v[18:19], v[16:17], v[122:123], v[18:19] op_sel:[1,1,0] op_sel_hi:[1,0,1] neg_lo:[0,1,0]
    v_pk_mul_f32 v[66:67], v[62:63], v[62:63] op_sel:[0,0] op_sel_hi:[0,1]
    v_pk_mul_f32 v[64:65], v[62:63], v[60:61] op_sel:[0,0] op_sel_hi:[0,1]
    buffer_load_dwordx4 a[16:19], v236, s[48:51], s4 offen offset:0 sc1
    v_cvt_pk_bf16_f32 v132, v32, -v33
    v_pk_fma_f32 v[66:67], v[62:63], v[62:63], v[66:67] op_sel:[1,1,0] op_sel_hi:[1,0,1] neg_lo:[0,1,0]
    v_pk_fma_f32 v[64:65], v[62:63], v[60:61], v[64:65] op_sel:[1,1,0] op_sel_hi:[1,0,1] neg_lo:[0,1,0]
    ds_write_b32 v13, v132 offset:21120
    v_cvt_pk_bf16_f32 v130, v62, v63
    v_pk_mul_f32 v[126:127], v[124:125], v[124:125] op_sel:[0,0] op_sel_hi:[0,1]
    v_cvt_pk_bf16_f32 v132, v18, -v19
    ds_write_b32 v13, v130 offset:1056
    v_pk_fma_f32 v[126:127], v[124:125], v[124:125], v[126:127] op_sel:[1,1,0] op_sel_hi:[1,0,1] neg_lo:[0,1,0]
    ds_write_b32 v13, v132 offset:17424
    v_pk_mul_f32 v[68:69], v[60:61], v[66:67] op_sel:[0,0] op_sel_hi:[0,1]
    v_pk_mul_f32 v[70:71], v[62:63], v[66:67] op_sel:[0,0] op_sel_hi:[0,1]
    buffer_load_dwordx4 a[20:23], v237, s[48:51], s4 offen offset:0 sc1
    v_pk_mul_f32 v[72:73], v[64:65], v[66:67] op_sel:[0,0] op_sel_hi:[0,1]
    v_pk_mul_f32 v[74:75], v[66:67], v[66:67] op_sel:[0,0] op_sel_hi:[0,1]
    v_pk_mul_f32 v[20:21], v[18:19], v[122:123] op_sel:[0,0] op_sel_hi:[0,1]
    v_pk_mul_f32 v[40:41], v[32:33], v[128:129] op_sel:[0,0] op_sel_hi:[0,1]
    v_pk_fma_f32 v[68:69], v[60:61], v[66:67], v[68:69] op_sel:[1,1,0] op_sel_hi:[1,0,1] neg_lo:[0,1,0]
    v_pk_fma_f32 v[70:71], v[62:63], v[66:67], v[70:71] op_sel:[1,1,0] op_sel_hi:[1,0,1] neg_lo:[0,1,0]
    v_pk_fma_f32 v[72:73], v[64:65], v[66:67], v[72:73] op_sel:[1,1,0] op_sel_hi:[1,0,1] neg_lo:[0,1,0]
    v_pk_fma_f32 v[74:75], v[66:67], v[66:67], v[74:75] op_sel:[1,1,0] op_sel_hi:[1,0,1] neg_lo:[0,1,0]
    v_pk_fma_f32 v[20:21], v[18:19], v[122:123], v[20:21] op_sel:[1,1,0] op_sel_hi:[1,0,1] neg_lo:[0,1,0]
    v_pk_fma_f32 v[40:41], v[32:33], v[128:129], v[40:41] op_sel:[1,1,0] op_sel_hi:[1,0,1] neg_lo:[0,1,0]
    v_pk_mul_f32 v[76:77], v[68:69], v[66:67] op_sel:[0,0] op_sel_hi:[0,1]
    v_pk_mul_f32 v[78:79], v[70:71], v[66:67] op_sel:[0,0] op_sel_hi:[0,1]
    v_cvt_pk_bf16_f32 v135, v64, v65
    buffer_load_dwordx4 a[24:27], v236, s[48:51], s4 offen offset:2048 sc1
    v_cvt_pk_bf16_f32 v136, v66, v67
    v_cvt_pk_bf16_f32 v137, v20, -v21
    v_cvt_pk_bf16_f32 v138, v40, -v41
    v_pk_fma_f32 v[76:77], v[68:69], v[66:67], v[76:77] op_sel:[1,1,0] op_sel_hi:[1,0,1] neg_lo:[0,1,0]
    v_pk_fma_f32 v[78:79], v[70:71], v[66:67], v[78:79] op_sel:[1,1,0] op_sel_hi:[1,0,1] neg_lo:[0,1,0]
    ds_write_b32 v13, v135 offset:1584
    ds_write_b32 v13, v136 offset:2112
    ds_write_b32 v13, v137 offset:17952
    ds_write_b32 v13, v138 offset:23232
    v_cvt_pk_bf16_f32 v133, v68, v69
    v_cvt_pk_bf16_f32 v134, v70, v71
    v_pk_mul_f32 v[80:81], v[72:73], v[66:67] op_sel:[0,0] op_sel_hi:[0,1]
    buffer_load_dwordx4 a[28:31], v237, s[48:51], s4 offen offset:2048 sc1
    s_add_u32 s4, s4, 4096
    v_pk_mul_f32 v[82:83], v[74:75], v[66:67] op_sel:[0,0] op_sel_hi:[0,1]
    v_pk_mul_f32 v[22:23], v[20:21], v[122:123] op_sel:[0,0] op_sel_hi:[0,1]
    v_pk_mul_f32 v[42:43], v[40:41], v[126:127] op_sel:[0,0] op_sel_hi:[0,1]
    ds_write_b32 v13, v133 offset:2640
    ds_write_b32 v13, v134 offset:3168
    v_pk_fma_f32 v[80:81], v[72:73], v[66:67], v[80:81] op_sel:[1,1,0] op_sel_hi:[1,0,1] neg_lo:[0,1,0]
    v_pk_fma_f32 v[82:83], v[74:75], v[66:67], v[82:83] op_sel:[1,1,0] op_sel_hi:[1,0,1] neg_lo:[0,1,0]
    v_pk_fma_f32 v[22:23], v[20:21], v[122:123], v[22:23] op_sel:[1,1,0] op_sel_hi:[1,0,1] neg_lo:[0,1,0]
    v_pk_fma_f32 v[42:43], v[40:41], v[126:127], v[42:43] op_sel:[1,1,0] op_sel_hi:[1,0,1] neg_lo:[0,1,0]
    v_pk_mul_f32 v[84:85], v[76:77], v[66:67] op_sel:[0,0] op_sel_hi:[0,1]
    v_pk_mul_f32 v[86:87], v[78:79], v[66:67] op_sel:[0,0] op_sel_hi:[0,1]
    v_cvt_pk_bf16_f32 v135, v72, v73
    buffer_load_dwordx4 a[32:35], v236, s[48:51], s4 offen offset:0 sc1
    v_cvt_pk_bf16_f32 v136, v74, v75
    v_cvt_pk_bf16_f32 v137, v22, -v23
    v_cvt_pk_bf16_f32 v138, v42, -v43
    v_pk_fma_f32 v[84:85], v[76:77], v[66:67], v[84:85] op_sel:[1,1,0] op_sel_hi:[1,0,1] neg_lo:[0,1,0]
    v_pk_fma_f32 v[86:87], v[78:79], v[66:67], v[86:87] op_sel:[1,1,0] op_sel_hi:[1,0,1] neg_lo:[0,1,0]
    ds_write_b32 v13, v135 offset:3696
    ds_write_b32 v13, v136 offset:4224
    ds_write_b32 v13, v137 offset:18480
    ds_write_b32 v13, v138 offset:23760
    v_cvt_pk_bf16_f32 v133, v76, v77
    v_cvt_pk_bf16_f32 v134, v78, v79
    v_pk_mul_f32 v[88:89], v[80:81], v[66:67] op_sel:[0,0] op_sel_hi:[0,1]
    buffer_load_dwordx4 a[36:39], v237, s[48:51], s4 offen offset:0 sc1
    v_pk_mul_f32 v[90:91], v[82:83], v[66:67] op_sel:[0,0] op_sel_hi:[0,1]
    v_pk_mul_f32 v[24:25], v[22:23], v[122:123] op_sel:[0,0] op_sel_hi:[0,1]
    v_pk_mul_f32 v[44:45], v[40:41], v[128:129] op_sel:[0,0] op_sel_hi:[0,1]
    ds_write_b32 v13, v133 offset:4752
    ds_write_b32 v13, v134 offset:5280
    v_pk_fma_f32 v[88:89], v[80:81], v[66:67], v[88:89] op_sel:[1,1,0] op_sel_hi:[1,0,1] neg_lo:[0,1,0]
    v_pk_fma_f32 v[90:91], v[82:83], v[66:67], v[90:91] op_sel:[1,1,0] op_sel_hi:[1,0,1] neg_lo:[0,1,0]
    v_pk_fma_f32 v[24:25], v[22:23], v[122:123], v[24:25] op_sel:[1,1,0] op_sel_hi:[1,0,1] neg_lo:[0,1,0]
    v_pk_fma_f32 v[44:45], v[40:41], v[128:129], v[44:45] op_sel:[1,1,0] op_sel_hi:[1,0,1] neg_lo:[0,1,0]
    v_pk_mul_f32 v[92:93], v[84:85], v[66:67] op_sel:[0,0] op_sel_hi:[0,1]
    v_pk_mul_f32 v[94:95], v[86:87], v[66:67] op_sel:[0,0] op_sel_hi:[0,1]
    v_cvt_pk_bf16_f32 v135, v80, v81
    buffer_load_dwordx4 a[40:43], v236, s[48:51], s4 offen offset:2048 sc1
    v_cvt_pk_bf16_f32 v136, v82, v83
    v_cvt_pk_bf16_f32 v137, v24, -v25
    v_cvt_pk_bf16_f32 v138, v44, -v45
    v_pk_fma_f32 v[92:93], v[84:85], v[66:67], v[92:93] op_sel:[1,1,0] op_sel_hi:[1,0,1] neg_lo:[0,1,0]
    v_pk_fma_f32 v[94:95], v[86:87], v[66:67], v[94:95] op_sel:[1,1,0] op_sel_hi:[1,0,1] neg_lo:[0,1,0]
    ds_write_b32 v13, v135 offset:5808
    ds_write_b32 v13, v136 offset:6336
    ds_write_b32 v13, v137 offset:19008
    ds_write_b32 v13, v138 offset:24288
    v_cvt_pk_bf16_f32 v133, v84, v85
    v_cvt_pk_bf16_f32 v134, v86, v87
    v_pk_mul_f32 v[96:97], v[88:89], v[66:67] op_sel:[0,0] op_sel_hi:[0,1]
    buffer_load_dwordx4 a[44:47], v237, s[48:51], s4 offen offset:2048 sc1
    s_add_u32 s4, s4, 4096
    v_pk_mul_f32 v[98:99], v[90:91], v[66:67] op_sel:[0,0] op_sel_hi:[0,1]
    v_pk_mul_f32 v[26:27], v[24:25], v[122:123] op_sel:[0,0] op_sel_hi:[0,1]
    v_pk_mul_f32 v[46:47], v[44:45], v[126:127] op_sel:[0,0] op_sel_hi:[0,1]
    ds_write_b32 v13, v133 offset:6864
    ds_write_b32 v13, v134 offset:7392
    v_pk_fma_f32 v[96:97], v[88:89], v[66:67], v[96:97] op_sel:[1,1,0] op_sel_hi:[1,0,1] neg_lo:[0,1,0]
    v_pk_fma_f32 v[98:99], v[90:91], v[66:67], v[98:99] op_sel:[1,1,0] op_sel_hi:[1,0,1] neg_lo:[0,1,0]
    v_pk_fma_f32 v[26:27], v[24:25], v[122:123], v[26:27] op_sel:[1,1,0] op_sel_hi:[1,0,1] neg_lo:[0,1,0]
    v_pk_fma_f32 v[46:47], v[44:45], v[126:127], v[46:47] op_sel:[1,1,0] op_sel_hi:[1,0,1] neg_lo:[0,1,0]
    v_pk_mul_f32 v[100:101], v[92:93], v[66:67] op_sel:[0,0] op_sel_hi:[0,1]
    v_pk_mul_f32 v[102:103], v[94:95], v[66:67] op_sel:[0,0] op_sel_hi:[0,1]
    v_cvt_pk_bf16_f32 v135, v88, v89
    buffer_load_dwordx4 a[48:51], v236, s[48:51], s4 offen offset:0 sc1
    v_cvt_pk_bf16_f32 v136, v90, v91
    v_cvt_pk_bf16_f32 v137, v26, -v27
    v_cvt_pk_bf16_f32 v138, v46, -v47
    v_pk_fma_f32 v[100:101], v[92:93], v[66:67], v[100:101] op_sel:[1,1,0] op_sel_hi:[1,0,1] neg_lo:[0,1,0]
    v_pk_fma_f32 v[102:103], v[94:95], v[66:67], v[102:103] op_sel:[1,1,0] op_sel_hi:[1,0,1] neg_lo:[0,1,0]
    ds_write_b32 v13, v135 offset:7920
    ds_write_b32 v13, v136 offset:8448
    ds_write_b32 v13, v137 offset:19536
    ds_write_b32 v13, v138 offset:24816
    v_cvt_pk_bf16_f32 v133, v92, v93
    v_cvt_pk_bf16_f32 v134, v94, v95
    v_pk_mul_f32 v[104:105], v[96:97], v[66:67] op_sel:[0,0] op_sel_hi:[0,1]
    buffer_load_dwordx4 a[52:55], v237, s[48:51], s4 offen offset:0 sc1
    v_pk_mul_f32 v[106:107], v[98:99], v[66:67] op_sel:[0,0] op_sel_hi:[0,1]
    v_pk_mul_f32 v[28:29], v[26:27], v[122:123] op_sel:[0,0] op_sel_hi:[0,1]
    v_pk_mul_f32 v[48:49], v[44:45], v[128:129] op_sel:[0,0] op_sel_hi:[0,1]
    ds_write_b32 v13, v133 offset:8976
    ds_write_b32 v13, v134 offset:9504
    v_pk_fma_f32 v[104:105], v[96:97], v[66:67], v[104:105] op_sel:[1,1,0] op_sel_hi:[1,0,1] neg_lo:[0,1,0]
    v_pk_fma_f32 v[106:107], v[98:99], v[66:67], v[106:107] op_sel:[1,1,0] op_sel_hi:[1,0,1] neg_lo:[0,1,0]
    v_pk_fma_f32 v[28:29], v[26:27], v[122:123], v[28:29] op_sel:[1,1,0] op_sel_hi:[1,0,1] neg_lo:[0,1,0]
    v_pk_fma_f32 v[48:49], v[44:45], v[128:129], v[48:49] op_sel:[1,1,0] op_sel_hi:[1,0,1] neg_lo:[0,1,0]
    v_pk_mul_f32 v[108:109], v[100:101], v[66:67] op_sel:[0,0] op_sel_hi:[0,1]
    v_pk_mul_f32 v[110:111], v[102:103], v[66:67] op_sel:[0,0] op_sel_hi:[0,1]
    v_cvt_pk_bf16_f32 v135, v96, v97
    buffer_load_dwordx4 a[56:59], v236, s[48:51], s4 offen offset:2048 sc1
    v_cvt_pk_bf16_f32 v136, v98, v99
    v_cvt_pk_bf16_f32 v137, v28, -v29
    v_cvt_pk_bf16_f32 v138, v48, -v49
    v_pk_fma_f32 v[108:109], v[100:101], v[66:67], v[108:109] op_sel:[1,1,0] op_sel_hi:[1,0,1] neg_lo:[0,1,0]
    v_pk_fma_f32 v[110:111], v[102:103], v[66:67], v[110:111] op_sel:[1,1,0] op_sel_hi:[1,0,1] neg_lo:[0,1,0]
    ds_write_b32 v13, v135 offset:10032
    ds_write_b32 v13, v136 offset:10560
    ds_write_b32 v13, v137 offset:20064
    ds_write_b32 v13, v138 offset:25344
    v_cvt_pk_bf16_f32 v133, v100, v101
    v_cvt_pk_bf16_f32 v134, v102, v103
    v_pk_mul_f32 v[112:113], v[104:105], v[66:67] op_sel:[0,0] op_sel_hi:[0,1]
    buffer_load_dwordx4 a[60:63], v237, s[48:51], s4 offen offset:2048 sc1
    s_add_u32 s4, s4, 4096
    v_pk_mul_f32 v[114:115], v[106:107], v[66:67] op_sel:[0,0] op_sel_hi:[0,1]
    v_pk_mul_f32 v[30:31], v[28:29], v[122:123] op_sel:[0,0] op_sel_hi:[0,1]
    v_pk_mul_f32 v[50:51], v[48:49], v[128:129] op_sel:[0,0] op_sel_hi:[0,1]
    ds_write_b32 v13, v133 offset:11088
    ds_write_b32 v13, v134 offset:11616
    v_pk_fma_f32 v[112:113], v[104:105], v[66:67], v[112:113] op_sel:[1,1,0] op_sel_hi:[1,0,1] neg_lo:[0,1,0]
    v_pk_fma_f32 v[114:115], v[106:107], v[66:67], v[114:115] op_sel:[1,1,0] op_sel_hi:[1,0,1] neg_lo:[0,1,0]
    v_pk_fma_f32 v[30:31], v[28:29], v[122:123], v[30:31] op_sel:[1,1,0] op_sel_hi:[1,0,1] neg_lo:[0,1,0]
    v_pk_fma_f32 v[50:51], v[48:49], v[128:129], v[50:51] op_sel:[1,1,0] op_sel_hi:[1,0,1] neg_lo:[0,1,0]
    v_pk_mul_f32 v[116:117], v[108:109], v[66:67] op_sel:[0,0] op_sel_hi:[0,1]
    v_pk_mul_f32 v[118:119], v[110:111], v[66:67] op_sel:[0,0] op_sel_hi:[0,1]
    v_cvt_pk_bf16_f32 v135, v104, v105
    buffer_load_dwordx4 a[64:67], v236, s[48:51], s4 offen offset:0 sc1
    v_cvt_pk_bf16_f32 v136, v106, v107
    v_cvt_pk_bf16_f32 v137, v30, -v31
    v_cvt_pk_bf16_f32 v138, v50, -v51
    v_pk_fma_f32 v[116:117], v[108:109], v[66:67], v[116:117] op_sel:[1,1,0] op_sel_hi:[1,0,1] neg_lo:[0,1,0]
    v_pk_fma_f32 v[118:119], v[110:111], v[66:67], v[118:119] op_sel:[1,1,0] op_sel_hi:[1,0,1] neg_lo:[0,1,0]
    ds_write_b32 v13, v135 offset:12144
    ds_write_b32 v13, v136 offset:12672
    ds_write_b32 v13, v137 offset:20592
    ds_write_b32 v13, v138 offset:25872
    v_cvt_pk_bf16_f32 v133, v108, v109
    v_cvt_pk_bf16_f32 v134, v110, v111
    v_pk_mul_f32 v[120:121], v[112:113], v[66:67] op_sel:[0,0] op_sel_hi:[0,1]
    buffer_load_dwordx4 a[68:71], v237, s[48:51], s4 offen offset:0 sc1
    v_cvt_pk_bf16_f32 v136, v114, v115
    v_pk_mul_f32 v[34:35], v[32:33], v[124:125] op_sel:[0,0] op_sel_hi:[0,1]
    v_pk_mul_f32 v[52:53], v[50:51], v[128:129] op_sel:[0,0] op_sel_hi:[0,1]
    ds_write_b32 v13, v133 offset:13200
    ds_write_b32 v13, v134 offset:13728
    v_pk_fma_f32 v[120:121], v[112:113], v[66:67], v[120:121] op_sel:[1,1,0] op_sel_hi:[1,0,1] neg_lo:[0,1,0]
    ds_write_b32 v13, v136 offset:14784
    v_pk_fma_f32 v[34:35], v[32:33], v[124:125], v[34:35] op_sel:[1,1,0] op_sel_hi:[1,0,1] neg_lo:[0,1,0]
    v_pk_fma_f32 v[52:53], v[50:51], v[128:129], v[52:53] op_sel:[1,1,0] op_sel_hi:[1,0,1] neg_lo:[0,1,0]
    v_cvt_pk_bf16_f32 v133, v116, v117
    v_cvt_pk_bf16_f32 v134, v118, v119
    v_cvt_pk_bf16_f32 v135, v112, v113
    v_cvt_pk_bf16_f32 v137, v34, -v35
    v_cvt_pk_bf16_f32 v138, v52, -v53
    ds_write_b32 v13, v133 offset:15312
    ds_write_b32 v13, v134 offset:15840
    ds_write_b32 v13, v135 offset:14256
    ds_write_b32 v13, v137 offset:21648
    ds_write_b32 v13, v138 offset:26400
    v_cvt_pk_bf16_f32 v135, v120, v121
    v_pk_mul_f32 v[36:37], v[34:35], v[124:125] op_sel:[0,0] op_sel_hi:[0,1]
    v_pk_mul_f32 v[54:55], v[52:53], v[128:129] op_sel:[0,0] op_sel_hi:[0,1]
    ds_write_b32 v13, v135 offset:16368
    v_pk_fma_f32 v[36:37], v[34:35], v[124:125], v[36:37] op_sel:[1,1,0] op_sel_hi:[1,0,1] neg_lo:[0,1,0]
    v_pk_fma_f32 v[54:55], v[52:53], v[128:129], v[54:55] op_sel:[1,1,0] op_sel_hi:[1,0,1] neg_lo:[0,1,0]
    s_waitcnt vmcnt(18)
    s_add_u32 s11, s11, 16
    s_mov_b64 exec, 1
    buffer_store_dword v238, off, s[48:51], s11 sc1
    s_mov_b64 exec, -1
    v_cvt_pk_bf16_f32 v137, v36, -v37
    v_cvt_pk_bf16_f32 v138, v54, -v55
    ds_write_b32 v13, v137 offset:22176
    ds_write_b32 v13, v138 offset:26928
    v_pk_mul_f32 v[38:39], v[36:37], v[124:125] op_sel:[0,0] op_sel_hi:[0,1]
    v_pk_mul_f32 v[56:57], v[54:55], v[128:129] op_sel:[0,0] op_sel_hi:[0,1]
    v_pk_fma_f32 v[38:39], v[36:37], v[124:125], v[38:39] op_sel:[1,1,0] op_sel_hi:[1,0,1] neg_lo:[0,1,0]
    v_pk_fma_f32 v[56:57], v[54:55], v[128:129], v[56:57] op_sel:[1,1,0] op_sel_hi:[1,0,1] neg_lo:[0,1,0]
    v_cvt_pk_bf16_f32 v137, v38, -v39
    v_cvt_pk_bf16_f32 v138, v56, -v57
    s_mov_b64 exec, s[14:15]
    buffer_load_dwordx2 v[244:245], v241, s[48:51], 0 offen sc1
    s_mov_b64 exec, -1
    ds_write_b32 v13, v137 offset:22704
    ds_write_b32 v13, v138 offset:27456
    s_lshr_b32 s80, s66, 1
    s_mul_i32 s80, s80, 65536
    s_add_u32 s80, s80, 65536
    s_and_b32 s81, s66, 1
    s_mul_i32 s81, s81, 8448
    s_mov_b32 s83, 528
    v_and_b32 v2, 15, v255
    v_lshrrev_b32 v3, 4, v255
    v_lshl_add_u32 v3, v3, 4, s80
    v_mad_u32_u24 v140, v2, s83, v3
    v_min_u32 v2, 4, v2
    v_mad_u32_u24 v142, v2, s83, v3
    v_add_u32 v141, s81, v140
    s_waitcnt lgkmcnt(0)
    s_barrier
    ds_read_b128 v[16:19], v141 offset:0
    ds_read_b128 v[20:23], v140 offset:16896
    ds_read_b128 v[24:27], v142 offset:25344
    ds_read_b128 v[28:31], v141 offset:64
    ds_read_b128 v[32:35], v140 offset:16960
    ds_read_b128 v[36:39], v142 offset:25408
    ds_read_b128 v[40:43], v141 offset:128
    ds_read_b128 v[44:47], v140 offset:17024
    ds_read_b128 v[48:51], v142 offset:25472
    ds_read_b128 v[52:55], v141 offset:192
    ds_read_b128 v[56:59], v140 offset:17088
    ds_read_b128 v[60:63], v142 offset:25536
    s_waitcnt lgkmcnt(10)
    v_mfma_f32_16x16x32_bf16 v[4:7], v[20:23], v[16:19], 0
    s_waitcnt lgkmcnt(9)
    v_mfma_f32_16x16x32_bf16 v[8:11], v[24:27], v[16:19], 0
    ds_read_b128 v[64:67], v141 offset:256
    ds_read_b128 v[68:71], v140 offset:17152
    ds_read_b128 v[72:75], v142 offset:25600
    s_waitcnt lgkmcnt(10)
    v_mfma_f32_16x16x32_bf16 v[4:7], v[32:35], v[28:31], v[4:7]
    s_waitcnt lgkmcnt(9)
    v_mfma_f32_16x16x32_bf16 v[8:11], v[36:39], v[28:31], v[8:11]
    ds_read_b128 v[76:79], v141 offset:320
    ds_read_b128 v[80:83], v140 offset:17216
    ds_read_b128 v[84:87], v142 offset:25664
    s_waitcnt lgkmcnt(10)
    v_mfma_f32_16x16x32_bf16 v[4:7], v[44:47], v[40:43], v[4:7]
    s_waitcnt lgkmcnt(9)
    v_mfma_f32_16x16x32_bf16 v[8:11], v[48:51], v[40:43], v[8:11]
    ds_read_b128 v[88:91], v141 offset:384
    ds_read_b128 v[92:95], v140 offset:17280
    ds_read_b128 v[96:99], v142 offset:25728
    s_waitcnt lgkmcnt(10)
    v_mfma_f32_16x16x32_bf16 v[4:7], v[56:59], v[52:55], v[4:7]
    s_waitcnt lgkmcnt(9)
    v_mfma_f32_16x16x32_bf16 v[8:11], v[60:63], v[52:55], v[8:11]
    ds_read_b128 v[100:103], v141 offset:448
    ds_read_b128 v[104:107], v140 offset:17344
    ds_read_b128 v[108:111], v142 offset:25792
    s_waitcnt lgkmcnt(10)
    v_mfma_f32_16x16x32_bf16 v[4:7], v[68:71], v[64:67], v[4:7]
    s_waitcnt lgkmcnt(9)
    v_mfma_f32_16x16x32_bf16 v[8:11], v[72:75], v[64:67], v[8:11]
    s_waitcnt lgkmcnt(7)
    v_mfma_f32_16x16x32_bf16 v[4:7], v[80:83], v[76:79], v[4:7]
    s_waitcnt lgkmcnt(6)
    v_mfma_f32_16x16x32_bf16 v[8:11], v[84:87], v[76:79], v[8:11]
    s_waitcnt lgkmcnt(4)
    v_mfma_f32_16x16x32_bf16 v[4:7], v[92:95], v[88:91], v[4:7]
    s_waitcnt lgkmcnt(3)
    v_mfma_f32_16x16x32_bf16 v[8:11], v[96:99], v[88:91], v[8:11]
    s_waitcnt lgkmcnt(1)
    v_mfma_f32_16x16x32_bf16 v[4:7], v[104:107], v[100:103], v[4:7]
    s_waitcnt lgkmcnt(0)
    v_mfma_f32_16x16x32_bf16 v[8:11], v[108:111], v[100:103], v[8:11]
    s_nop 5
    v_add_f32 v4, v4, v223
    v_cvt_pk_bf16_f32 v5, v4, v5
    v_cvt_pk_bf16_f32 v6, v6, v7
    v_cvt_pk_bf16_f32 v8, v8, v9
    v_cvt_pk_bf16_f32 v10, v10, v11
    ds_write_b32 v219, v5
    ds_write_b32 v220, v6
    ds_write_b16 v221, v8 offset:1024
    ds_write_b16_d16_hi v221, v8 offset:1088
    ds_write_b16 v221, v10 offset:1152
    ds_write_b16_d16_hi v221, v10 offset:1216
    s_mov_b64 exec, s[14:15]
    s_waitcnt vmcnt(0)
    v_and_b32 v244, v244, v245
    v_cmp_ne_u32 vcc, 1, v244
    s_mov_b64 exec, -1
    s_nop 3
    s_cbranch_vccnz L_slow_27
L_ret_28:
    s_waitcnt lgkmcnt(0)
    s_barrier
    s_lshr_b32 s80, s77, 1
    s_lshl_b32 s80, s80, 14
    s_and_b32 s81, s77, 1
    s_lshl_b32 s81, s81, 5
    s_add_u32 s80, s80, s81
    s_lshl_b32 s81, s66, 11
    s_add_u32 s80, s80, s81
    s_add_u32 s80, s80, 3145728
    s_add_u32 s81, s80, 8192
    v_lshrrev_b32 v232, 1, v255
    v_and_b32 v233, 1, v255
    v_lshlrev_b32 v233, 4, v233
    v_lshl_add_u32 v232, v232, 6, v233
    buffer_load_dwordx4 v[224:227], v232, s[48:51], s80 offen sc1
    buffer_load_dwordx4 v[228:231], v232, s[48:51], s81 offen sc1
    v_mov_b32 v196, 0
    v_mov_b32 v197, 0
    v_mov_b32 v198, 0
    v_mov_b32 v199, 0
    ds_write_b128 v222, v[196:199]
    s_lshr_b32 s80, s66, 1
    s_mul_i32 s80, s80, 8320
    s_and_b32 s81, s66, 1
    s_lshl_b32 s81, s81, 11
    s_add_u32 s80, s80, s81
    s_add_u32 s80, s80, 131072
    v_lshl_add_u32 v200, v255, 5, s80
    ds_read_u16 v210, v210
    ds_read_u16 v202, v202
    ds_read_u16 v211, v211
    ds_read_u16 v203, v203
    ds_read_u16 v212, v212
    ds_read_u16 v204, v204
    ds_read_u16 v213, v213
    ds_read_u16 v205, v205
    ds_read_u16 v214, v214
    ds_read_u16 v206, v206
    ds_read_u16 v215, v215
    ds_read_u16 v207, v207
    ds_read_u16 v216, v216
    ds_read_u16 v208, v208
    ds_read_u16 v217, v217
    ds_read_u16 v209, v209
    ds_read_u16 v218, v218
    buffer_load_dwordx4 a[72:75], v236, s[48:51], s4 offen offset:2048 sc1
    buffer_load_dwordx4 a[76:79], v237, s[48:51], s4 offen offset:2048 sc1
    s_add_u32 s4, s4, 4096
    buffer_load_dwordx4 a[80:83], v236, s[48:51], s4 offen offset:0 sc1
    buffer_load_dwordx4 a[84:87], v237, s[48:51], s4 offen offset:0 sc1
    s_waitcnt lgkmcnt(15)
    v_lshl_or_b32 v192, v202, 16, v210
    s_waitcnt lgkmcnt(14)
    v_lshl_or_b32 v202, v211, 16, v202
    s_waitcnt lgkmcnt(13)
    v_lshl_or_b32 v193, v203, 16, v211
    s_waitcnt lgkmcnt(12)
    v_lshl_or_b32 v203, v212, 16, v203
    s_waitcnt lgkmcnt(11)
    v_lshl_or_b32 v194, v204, 16, v212
    s_waitcnt lgkmcnt(10)
    v_lshl_or_b32 v204, v213, 16, v204
    s_waitcnt lgkmcnt(9)
    v_lshl_or_b32 v195, v205, 16, v213
    s_waitcnt lgkmcnt(8)
    v_lshl_or_b32 v205, v214, 16, v205
    ds_write_b128 v200, v[192:195] offset:0
    ds_write_b128 v200, v[202:205] offset:4160
    s_waitcnt lgkmcnt(9)
    v_lshl_or_b32 v196, v206, 16, v214
    s_waitcnt lgkmcnt(8)
    v_lshl_or_b32 v206, v215, 16, v206
    s_waitcnt lgkmcnt(7)
    v_lshl_or_b32 v197, v207, 16, v215
    s_waitcnt lgkmcnt(6)
    v_lshl_or_b32 v207, v216, 16, v207
    s_waitcnt lgkmcnt(5)
    v_lshl_or_b32 v198, v208, 16, v216
    s_waitcnt lgkmcnt(4)
    v_lshl_or_b32 v208, v217, 16, v208
    s_waitcnt lgkmcnt(3)
    v_lshl_or_b32 v199, v209, 16, v217
    s_waitcnt lgkmcnt(2)
    v_lshl_or_b32 v209, v218, 16, v209
    ds_write_b128 v200, v[196:199] offset:16
    ds_write_b128 v200, v[206:209] offset:4176
    buffer_load_dwordx4 a[88:91], v236, s[48:51], s4 offen offset:2048 sc1
    buffer_load_dwordx4 a[92:95], v237, s[48:51], s4 offen offset:2048 sc1
    s_add_u32 s4, s4, 4096
    buffer_load_dwordx4 a[96:99], v236, s[48:51], s4 offen offset:0 sc1
    buffer_load_dwordx4 a[100:103], v237, s[48:51], s4 offen offset:0 sc1
    buffer_load_dwordx4 a[104:107], v236, s[48:51], s4 offen offset:2048 sc1
    buffer_load_dwordx4 a[108:111], v237, s[48:51], s4 offen offset:2048 sc1
    s_add_u32 s4, s4, 4096
    buffer_load_dwordx4 a[112:115], v236, s[48:51], s4 offen offset:0 sc1
    buffer_load_dwordx4 a[116:119], v237, s[48:51], s4 offen offset:0 sc1
    buffer_load_dwordx4 a[120:123], v236, s[48:51], s4 offen offset:2048 sc1
    buffer_load_dwordx4 a[124:127], v237, s[48:51], s4 offen offset:2048 sc1
    s_add_u32 s4, s4, 4096
    buffer_load_dwordx4 a[128:131], v236, s[48:51], s4 offen offset:0 sc1
    buffer_load_dwordx4 a[132:135], v237, s[48:51], s4 offen offset:0 sc1
    buffer_load_dwordx4 a[136:139], v236, s[48:51], s4 offen offset:2048 sc1
    buffer_load_dwordx4 a[140:143], v237, s[48:51], s4 offen offset:2048 sc1
    s_add_u32 s4, s4, 4096
    s_lshl_b32 s80, s66, 9
    s_add_u32 s80, s80, 148224
    v_lshrrev_b32 v232, 1, v255
    v_and_b32 v233, 1, v255
    v_mul_u32_u24 v233, 4672, v233
    v_lshl_add_u32 v232, v232, 4, v233
    v_add_u32 v232, s80, v232
    s_waitcnt vmcnt(19)
    ds_write_b128 v232, v[224:227]
    s_waitcnt vmcnt(18)
    ds_write_b128 v232, v[228:231] offset:2048
    s_lshr_b32 s20, s66, 1
    s_and_b32 s21, s66, 1
    s_lshl_b32 s21, s21, 8
    s_mul_i32 s22, s20, 8320
    s_sub_u32 s22, s22, s21
    s_add_u32 s22, s22, 138588
    s_mul_i32 s23, s20, 4672
    s_sub_u32 s23, s23, s21
    s_add_u32 s23, s23, 148000
    v_and_b32 v192, 15, v255
    v_lshrrev_b32 v193, 4, v255
    v_lshlrev_b32 v193, 4, v193
    v_lshl_add_u32 v194, v192, 5, v193
    v_add_u32 v252, s23, v194
    v_and_b32 v194, 1, v255
    v_mul_u32_u24 v194, 4158, v194
    v_lshl_add_u32 v194, v192, 1, v194
    v_sub_u32 v194, v193, v194
    v_add_u32 v248, s22, v194
    v_subrev_u32 v249, 1024, v248
    v_subrev_u32 v250, 2048, v248
    v_subrev_u32 v251, 3072, v248
    s_lshl_b32 s20, s66, 13
    v_lshrrev_b32 v192, 5, v255
    v_lshlrev_b32 v192, 3, v192
    v_xor_b32 v192, v192, v255
    v_lshl_add_u32 v246, v192, 4, s20
    s_lshr_b32 s20, s66, 1
    s_lshl_b32 s20, s20, 14
    s_and_b32 s21, s66, 1
    s_lshl_b32 s21, s21, 12
    s_add_u32 s20, s20, s21
    v_and_b32 v192, 1, v255
    v_bfe_u32 v193, v255, 1, 4
    v_lshl_add_u32 v193, v192, 5, v193
    v_lshlrev_b32 v192, 3, v192
    v_xor_b32 v193, v193, v192
    v_lshrrev_b32 v192, 5, v255
    v_lshl_add_u32 v193, v192, 6, v193
    v_lshl_add_u32 v247, v193, 4, s20
    v_lshlrev_b32 v234, 4, v255
    s_lshl_b32 s20, s77, 2
    s_add_u32 s20, s20, s66
    s_lshl_b32 s20, s20, 11
    s_add_u32 s13, s20, 13631488
    s_waitcnt lgkmcnt(0)
    s_barrier
    ds_read2_b32 v[32:33], v248 offset0:176 offset1:177
    ds_read2_b32 v[34:35], v248 offset0:178 offset1:179
    ds_read_b128 v[64:67], v252 offset:192
    ds_read_b128 v[68:71], v252 offset:704
    ds_read_b128 v[72:75], v252 offset:1216
    ds_read_b128 v[76:79], v252 offset:1728
    ds_read_b128 v[80:83], v252 offset:2240
    ds_read_b128 v[84:87], v252 offset:2752
    ds_read_b128 v[88:91], v252 offset:3264
    ds_read_b128 v[92:95], v252 offset:3776
    ds_read2_b32 v[36:37], v248 offset0:48 offset1:49
    ds_read2_b32 v[38:39], v248 offset0:50 offset1:51
    s_waitcnt lgkmcnt(0)
    s_branch L_tail_3
L_slow_4:
    s_mov_b32 s86, 0x4000
L_spin_6:
    buffer_load_dword v244, v239, s[60:63], 0 offen sc1
    s_waitcnt vmcnt(0) lgkmcnt(0)
    v_cmp_ne_u32 vcc, 1, v244
    s_nop 4
    s_cbranch_vccz L_ret_5
    s_sleep 4
    s_sub_u32 s86, s86, 1
    s_cmp_lg_u32 s86, 0
    s_cbranch_scc1 L_spin_6
    s_branch L_ret_5
L_slow_7:
    s_mov_b32 s86, 0x4000
L_spin_9:
    buffer_load_dword v253, v240, s[48:51], 0 offen sc1
    s_waitcnt vmcnt(0) lgkmcnt(0)
    v_cmp_ne_u32 vcc, 1, v253
    s_nop 4
    s_cbranch_vccz L_ret_8
    s_sleep 4
    s_sub_u32 s86, s86, 1
    s_cmp_lg_u32 s86, 0
    s_cbranch_scc1 L_spin_9
    s_branch L_ret_8
L_slow_10:
    s_mov_b32 s86, 0x4000
L_spin_12:
    buffer_load_dwordx2 v[244:245], v241, s[48:51], 0 offen sc1
    s_waitcnt vmcnt(0) lgkmcnt(0)
    v_and_b32 v244, v244, v245
    v_cmp_ne_u32 vcc, 1, v244
    s_nop 4
    s_cbranch_vccz L_ret_11
    s_sleep 4
    s_sub_u32 s86, s86, 1
    s_cmp_lg_u32 s86, 0
    s_cbranch_scc1 L_spin_12
    s_branch L_ret_11
L_slow_13:
    s_mov_b32 s86, 0x4000
L_spin_15:
    buffer_load_dword v244, v242, s[48:51], 0 offen sc1
    s_waitcnt vmcnt(0) lgkmcnt(0)
    v_cmp_ne_u32 vcc, 1, v244
    s_nop 4
    s_cbranch_vccz L_ret_14
    s_sleep 4
    s_sub_u32 s86, s86, 1
    s_cmp_lg_u32 s86, 0
    s_cbranch_scc1 L_spin_15
    s_branch L_ret_14
L_slow_16:
    s_mov_b32 s86, 0x4000
L_spin_18:
    buffer_load_dword v244, v243, s[48:51], 0 offen sc1
    s_waitcnt vmcnt(0) lgkmcnt(0)
    v_cmp_ne_u32 vcc, 1, v244
    s_nop 4
    s_cbranch_vccz L_ret_17
    s_sleep 4
    s_sub_u32 s86, s86, 1
    s_cmp_lg_u32 s86, 0
    s_cbranch_scc1 L_spin_18
    s_branch L_ret_17
L_slow_21:
    s_mov_b32 s86, 0x4000
L_spin_23:
    buffer_load_dword v244, v239, s[60:63], 0 offen sc1
    s_waitcnt vmcnt(0) lgkmcnt(0)
    v_cmp_ne_u32 vcc, 1, v244
    s_nop 4
    s_cbranch_vccz L_ret_22
    s_sleep 4
    s_sub_u32 s86, s86, 1
    s_cmp_lg_u32 s86, 0
    s_cbranch_scc1 L_spin_23
    s_branch L_ret_22
L_slow_24:
    s_mov_b32 s86, 0x4000
L_spin_26:
    buffer_load_dword v253, v240, s[48:51], 0 offen sc1
    s_waitcnt vmcnt(0) lgkmcnt(0)
    v_cmp_ne_u32 vcc, 1, v253
    s_nop 4
    s_cbranch_vccz L_ret_25
    s_sleep 4
    s_sub_u32 s86, s86, 1
    s_cmp_lg_u32 s86, 0
    s_cbranch_scc1 L_spin_26
    s_branch L_ret_25
L_slow_27:
    s_mov_b32 s86, 0x4000
L_spin_29:
    buffer_load_dwordx2 v[244:245], v241, s[48:51], 0 offen sc1
    s_waitcnt vmcnt(0) lgkmcnt(0)
    v_and_b32 v244, v244, v245
    v_cmp_ne_u32 vcc, 1, v244
    s_nop 4
    s_cbranch_vccz L_ret_28
    s_sleep 4
    s_sub_u32 s86, s86, 1
    s_cmp_lg_u32 s86, 0
    s_cbranch_scc1 L_spin_29
    s_branch L_ret_28
L_end:
.section .rodata,"a"
.p2align 6
.amdhsa_kernel gated_mix__ssm_conv_s4d__glu_gated_reglu__prompt_kernel
  .amdhsa_next_free_vgpr 512
  .amdhsa_next_free_sgpr 102
  .amdhsa_accum_offset 256
  .amdhsa_group_segment_fixed_size 0
  .amdhsa_kernarg_size 120
  .amdhsa_user_sgpr_count 2
  .amdhsa_user_sgpr_kernarg_segment_ptr 1
  .amdhsa_system_sgpr_workgroup_id_x 1
.end_amdhsa_kernel
```
